```python
import torch

def _softmax(x, axis=-1):
    return torch.softmax(x, dim=axis)
def _gelu(x):
    return torch.nn.functional.gelu(x, approximate="tanh")
def _silu(x):
    return torch.nn.functional.silu(x)
def _sigmoid(x):
    return torch.sigmoid(x)
def _layernorm(x, axis=-1, eps=1e-5):
    m = x.mean(dim=axis, keepdim=True)
    v = x.var(dim=axis, keepdim=True, unbiased=False)
    return (x - m) / torch.sqrt(v + eps)
def _scatter_add(tgt, idx, src, axis=0):
    return tgt.clone().index_add_(axis, idx, src)
def _segment_sum(src, seg, n):
    out = torch.zeros((n,) + src.shape[1:], dtype=src.dtype)
    return out.index_add_(0, seg, src)
def _pad(x, pw):
    flat = tuple(v for pair in reversed(pw) for v in pair)
    return torch.nn.functional.pad(x, flat)

kernel_name = 'gather_scatter__edge_featured_mpnn_mpnn__graph'

def setup_inputs():

    _w = (lambda a: (lambda t: t.to(torch.bfloat16) if t.is_floating_point() else t)(torch.as_tensor(a)))
    N, deg, D, De = 12500, 32, 128, max(4, 1)
    E = N * deg
    H = 2 * D
    return {
        "x": _w((lambda *s: torch.randn(*s, dtype=torch.bfloat16) * 0.05)(N, D)),
        "e_attr": _w((lambda *s: torch.randn(*s, dtype=torch.bfloat16) * 1.6)(E, De)),
        "src": _w((lambda lo, hi, *s: torch.randint(lo, hi, s))(0, N, E).to(torch.int64)),
        "dst": _w((lambda lo, hi, *s: torch.randint(lo, hi, s))(0, N, E).to(torch.int64)),
        "w1": _w((lambda *s: torch.randn(*s, dtype=torch.bfloat16) * 1.6)(2 * D + De, H) * (1.0 / (2 * D + De) ** 0.5)),
        "b1": _w((lambda *s: torch.randn(*s, dtype=torch.bfloat16) * 3.2)(H) * 0.01),
        "w2": _w((lambda *s: torch.randn(*s, dtype=torch.bfloat16) * 0.05)(H, D) * (1.0 / H ** 0.5)),
        "b2": _w((lambda *s: torch.randn(*s, dtype=torch.bfloat16) * 0.1)(D) * 0.01),
    }

def reference(x, e_attr, src, dst, w1, b1, w2, b2):
    N, D = x.shape
    h_src = x[src]
    h_dst = x[dst]
    m_in = torch.concatenate([h_src, h_dst, e_attr], axis=-1)
    h = _silu(m_in @ w1 + b1)
    msg = h @ w2 + b2
    return _segment_sum(msg, dst, N)
```

```asm
; @launch kernel=prep_kernel grid=(256,1,1) block=(1024,1,1) lds=99840
; @launch kernel=main_kernel grid=(256,1,1) block=(1024,1,1) lds=143632
.amdgcn_target "amdgcn-amd-amdhsa--gfx950"
.text
.p2align 8
.globl prep_kernel
.type prep_kernel,@function
prep_kernel:
    s_cmp_ge_u32 s2, 256
    s_cbranch_scc1 K1_END
    s_sub_u32 s2, 255, s2
    s_load_dwordx8 s[4:11], s[0:1], 0
    s_load_dwordx4 s[12:15], s[0:1], 32
    s_load_dwordx2 s[16:17], s[0:1], 48
    s_load_dwordx2 s[18:19], s[0:1], 80
    v_lshlrev_b32 v3, 4, v0
    v_lshrrev_b32 v1, 6, v0
    v_and_b32 v2, 63, v0
    v_readfirstlane_b32 s3, v1
    s_mov_b32 s23, 0x00020000
    s_mov_b32 s27, 0x00020000
    s_mov_b32 s31, 0x00020000
    s_mov_b32 s22, 23109120
    s_sub_u32 s36, s2, 131
    s_cbranch_scc1 K1_GEMM
    s_mul_i32 s37, s36, 12800
    v_add_u32 v4, s37, v3
    v_lshlrev_b32 v5, 1, v4
    v_cmp_gt_u32 vcc, 800, v0
    s_cmp_ge_u32 s3, 13
    s_cbranch_scc1 K1_PACK
    s_mov_b64 s[46:47], vcc
    s_mov_b64 exec, vcc
    s_waitcnt lgkmcnt(0)
    global_load_dwordx4 v[8:11], v4, s[10:11]
    global_load_dwordx4 v[12:15], v4, s[8:9]
    global_load_dwordx4 v[16:19], v5, s[6:7]
    global_load_dwordx4 v[20:23], v5, s[6:7] offset:16
    s_branch K1_PART
K1_GEMM:
    s_mul_i32 s36, s2, 24576
    v_add_u32 v6, s36, v3
    v_add_u32 v4, 0x4000, v3
    v_add_u32 v5, 0x8000, v3
    v_add_u32 v7, 0xc000, v3
    v_add_u32 v8, 0x4000, v6
    s_mov_b32 s30, 3200000
    s_waitcnt lgkmcnt(0)
    s_mov_b32 s28, s4
    s_and_b32 s29, s5, 0xffff
    buffer_load_dwordx4 v[32:35], v6, s[28:31], 0 offen
    global_load_dwordx4 v[16:19], v3, s[12:13]
    global_load_dwordx4 v[20:23], v4, s[12:13]
    global_load_dwordx4 v[24:27], v5, s[12:13]
    global_load_dwordx4 v[28:31], v7, s[12:13]
    s_cmp_ge_u32 s3, 8
    s_cbranch_scc1 K1_G1
    buffer_load_dwordx4 v[36:39], v8, s[28:31], 0 offen
K1_G1:
    s_add_u32 s20, s18, 0
    s_addc_u32 s21, s19, 0
    s_cmp_lg_u32 s3, 15
    s_cbranch_scc1 K1_G3
    v_and_b32 v40, 1, v2
    v_mul_u32_u24 v40, 3219456, v40
    v_add_u32 v40, s36, v40
    buffer_load_dword v41, v40, s[20:23], 0 offen
K1_G3:
    v_lshrrev_b32 v4, 5, v0
    v_mul_u32_u24 v7, 576, v4
    v_and_b32 v9, 31, v2
    v_lshl_add_u32 v7, v9, 4, v7
    v_add_u32 v7, 26112, v7
    v_lshrrev_b32 v4, 4, v0
    v_mul_u32_u24 v8, 272, v4
    v_and_b32 v4, 15, v0
    v_lshl_add_u32 v8, v4, 4, v8
    s_lshr_b32 s36, s3, 2
    s_and_b32 s37, s3, 3
    v_lshrrev_b32 v10, 5, v2
    s_mul_i32 s38, s36, 8704
    v_mul_u32_u24 v11, 272, v9
    v_lshl_add_u32 v11, v10, 4, v11
    v_add_u32 v11, s38, v11
    v_bfe_u32 v12, v2, 2, 2
    v_lshl_add_u32 v12, v10, 3, v12
    v_mul_u32_u24 v12, 576, v12
    v_bfe_u32 v13, v2, 4, 1
    v_lshl_add_u32 v12, v13, 5, v12
    v_and_b32 v13, 3, v2
    v_lshl_add_u32 v12, v13, 3, v12
    s_lshl_b32 s38, s37, 7
    s_add_u32 s38, s38, 26112
    v_add_u32 v12, s38, v12
    v_add_u32 v13, 36864, v12
    s_lshr_b32 s39, s37, 1
    s_mul_i32 s39, s39, 3219456
    s_mul_i32 s40, s2, 24576
    s_add_u32 s39, s39, s40
    s_lshl_b32 s40, s36, 13
    s_add_u32 s39, s39, s40
    s_and_b32 s40, s37, 1
    s_lshl_b32 s40, s40, 7
    s_add_u32 s39, s39, s40
    v_lshlrev_b32 v14, 2, v9
    v_lshl_add_u32 v14, v10, 10, v14
    v_add_u32 v14, s39, v14
    v_add_u32 v15, 0x1000, v14
    s_mov_b32 s42, 0xbfb8aa3b
    s_mov_b32 s43, 0xbfb8aa3b
    v_add_u32 v6, 11501056, v6
    v_add_u32 v5, 0x4000, v6
    s_waitcnt vmcnt(4)
    ds_write_b128 v8, v[32:35] offset:0
    s_waitcnt vmcnt(3)
    ds_write_b128 v7, v[16:19] offset:0
    s_waitcnt vmcnt(2)
    ds_write_b128 v7, v[20:23] offset:18432
    s_waitcnt vmcnt(1)
    ds_write_b128 v7, v[24:27] offset:36864
    s_waitcnt vmcnt(0)
    ds_write_b128 v7, v[28:31] offset:55296
    s_cmp_ge_u32 s3, 8
    s_cbranch_scc1 K1_G2
    ds_write_b128 v8, v[36:39] offset:17408
K1_G2:
    s_waitcnt lgkmcnt(0)
    s_barrier
    s_cmp_ge_u32 s3, 12
    s_cbranch_scc1 K1_END
    ds_read_b128 v[16:19], v11 offset:0
    ds_read_b64_tr_b16 v[20:21], v12 offset:0
    ds_read_b64_tr_b16 v[22:23], v12 offset:2304
    ds_read_b64_tr_b16 v[24:25], v12 offset:64
    ds_read_b64_tr_b16 v[26:27], v12 offset:2368
    ds_read_b128 v[28:31], v11 offset:32
    ds_read_b64_tr_b16 v[32:33], v12 offset:9216
    ds_read_b64_tr_b16 v[34:35], v12 offset:11520
    ds_read_b64_tr_b16 v[36:37], v12 offset:9280
    ds_read_b64_tr_b16 v[38:39], v12 offset:11584
    ds_read_b128 v[40:43], v11 offset:64
    ds_read_b64_tr_b16 v[44:45], v12 offset:18432
    ds_read_b64_tr_b16 v[46:47], v12 offset:20736
    ds_read_b64_tr_b16 v[48:49], v12 offset:18496
    ds_read_b64_tr_b16 v[50:51], v12 offset:20800
    s_waitcnt lgkmcnt(10)
    v_mfma_f32_32x32x16_bf16 v[64:79], v[16:19], v[20:23], 0
    v_mfma_f32_32x32x16_bf16 v[80:95], v[16:19], v[24:27], 0
    ds_read_b128 v[52:55], v11 offset:96
    ds_read_b64_tr_b16 v[56:57], v12 offset:27648
    ds_read_b64_tr_b16 v[58:59], v12 offset:29952
    ds_read_b64_tr_b16 v[60:61], v12 offset:27712
    ds_read_b64_tr_b16 v[62:63], v12 offset:30016
    s_waitcnt lgkmcnt(10)
    v_mfma_f32_32x32x16_bf16 v[64:79], v[28:31], v[32:35], v[64:79]
    v_mfma_f32_32x32x16_bf16 v[80:95], v[28:31], v[36:39], v[80:95]
    ds_read_b128 v[16:19], v11 offset:128
    ds_read_b64_tr_b16 v[20:21], v13 offset:0
    ds_read_b64_tr_b16 v[22:23], v13 offset:2304
    ds_read_b64_tr_b16 v[24:25], v13 offset:64
    ds_read_b64_tr_b16 v[26:27], v13 offset:2368
    s_waitcnt lgkmcnt(10)
    v_mfma_f32_32x32x16_bf16 v[64:79], v[40:43], v[44:47], v[64:79]
    v_mfma_f32_32x32x16_bf16 v[80:95], v[40:43], v[48:51], v[80:95]
    ds_read_b128 v[28:31], v11 offset:160
    ds_read_b64_tr_b16 v[32:33], v13 offset:9216
    ds_read_b64_tr_b16 v[34:35], v13 offset:11520
    ds_read_b64_tr_b16 v[36:37], v13 offset:9280
    ds_read_b64_tr_b16 v[38:39], v13 offset:11584
    s_waitcnt lgkmcnt(10)
    v_mfma_f32_32x32x16_bf16 v[64:79], v[52:55], v[56:59], v[64:79]
    v_mfma_f32_32x32x16_bf16 v[80:95], v[52:55], v[60:63], v[80:95]
    ds_read_b128 v[40:43], v11 offset:192
    ds_read_b64_tr_b16 v[44:45], v13 offset:18432
    ds_read_b64_tr_b16 v[46:47], v13 offset:20736
    ds_read_b64_tr_b16 v[48:49], v13 offset:18496
    ds_read_b64_tr_b16 v[50:51], v13 offset:20800
    s_waitcnt lgkmcnt(10)
    v_mfma_f32_32x32x16_bf16 v[64:79], v[16:19], v[20:23], v[64:79]
    v_mfma_f32_32x32x16_bf16 v[80:95], v[16:19], v[24:27], v[80:95]
    ds_read_b128 v[52:55], v11 offset:224
    ds_read_b64_tr_b16 v[56:57], v13 offset:27648
    ds_read_b64_tr_b16 v[58:59], v13 offset:29952
    ds_read_b64_tr_b16 v[60:61], v13 offset:27712
    ds_read_b64_tr_b16 v[62:63], v13 offset:30016
    s_waitcnt lgkmcnt(10)
    v_mfma_f32_32x32x16_bf16 v[64:79], v[28:31], v[32:35], v[64:79]
    v_mfma_f32_32x32x16_bf16 v[80:95], v[28:31], v[36:39], v[80:95]
    s_waitcnt lgkmcnt(5)
    v_mfma_f32_32x32x16_bf16 v[64:79], v[40:43], v[44:47], v[64:79]
    v_mfma_f32_32x32x16_bf16 v[80:95], v[40:43], v[48:51], v[80:95]
    s_waitcnt lgkmcnt(0)
    v_mfma_f32_32x32x16_bf16 v[64:79], v[52:55], v[56:59], v[64:79]
    v_mfma_f32_32x32x16_bf16 v[80:95], v[52:55], v[60:63], v[80:95]
    s_nop 10
    v_mul_f32 v64, s42, v64
    v_mul_f32 v80, s42, v80
    v_cvt_pk_bf16_f32 v16, v64, v80
    buffer_store_dword v16, v14, s[20:23], 0 offen offset:0 sc1
    v_mul_f32 v65, s42, v65
    v_mul_f32 v81, s42, v81
    v_cvt_pk_bf16_f32 v17, v65, v81
    buffer_store_dword v17, v14, s[20:23], 0 offen offset:256 sc1
    v_mul_f32 v66, s42, v66
    v_mul_f32 v82, s42, v82
    v_cvt_pk_bf16_f32 v18, v66, v82
    buffer_store_dword v18, v14, s[20:23], 0 offen offset:512 sc1
    v_mul_f32 v67, s42, v67
    v_mul_f32 v83, s42, v83
    v_cvt_pk_bf16_f32 v19, v67, v83
    buffer_store_dword v19, v14, s[20:23], 0 offen offset:768 sc1
    v_mul_f32 v68, s42, v68
    v_mul_f32 v84, s42, v84
    v_cvt_pk_bf16_f32 v20, v68, v84
    buffer_store_dword v20, v14, s[20:23], 0 offen offset:2048 sc1
    v_mul_f32 v69, s42, v69
    v_mul_f32 v85, s42, v85
    v_cvt_pk_bf16_f32 v21, v69, v85
    buffer_store_dword v21, v14, s[20:23], 0 offen offset:2304 sc1
    v_mul_f32 v70, s42, v70
    v_mul_f32 v86, s42, v86
    v_cvt_pk_bf16_f32 v22, v70, v86
    buffer_store_dword v22, v14, s[20:23], 0 offen offset:2560 sc1
    v_mul_f32 v71, s42, v71
    v_mul_f32 v87, s42, v87
    v_cvt_pk_bf16_f32 v23, v71, v87
    buffer_store_dword v23, v14, s[20:23], 0 offen offset:2816 sc1
    v_mul_f32 v72, s42, v72
    v_mul_f32 v88, s42, v88
    v_cvt_pk_bf16_f32 v24, v72, v88
    buffer_store_dword v24, v15, s[20:23], 0 offen offset:0 sc1
    v_mul_f32 v73, s42, v73
    v_mul_f32 v89, s42, v89
    v_cvt_pk_bf16_f32 v25, v73, v89
    buffer_store_dword v25, v15, s[20:23], 0 offen offset:256 sc1
    v_mul_f32 v74, s42, v74
    v_mul_f32 v90, s42, v90
    v_cvt_pk_bf16_f32 v26, v74, v90
    buffer_store_dword v26, v15, s[20:23], 0 offen offset:512 sc1
    v_mul_f32 v75, s42, v75
    v_mul_f32 v91, s42, v91
    v_cvt_pk_bf16_f32 v27, v75, v91
    buffer_store_dword v27, v15, s[20:23], 0 offen offset:768 sc1
    v_mul_f32 v76, s42, v76
    v_mul_f32 v92, s42, v92
    v_cvt_pk_bf16_f32 v28, v76, v92
    buffer_store_dword v28, v15, s[20:23], 0 offen offset:2048 sc1
    v_mul_f32 v77, s42, v77
    v_mul_f32 v93, s42, v93
    v_cvt_pk_bf16_f32 v29, v77, v93
    buffer_store_dword v29, v15, s[20:23], 0 offen offset:2304 sc1
    v_mul_f32 v78, s42, v78
    v_mul_f32 v94, s42, v94
    v_cvt_pk_bf16_f32 v30, v78, v94
    buffer_store_dword v30, v15, s[20:23], 0 offen offset:2560 sc1
    v_mul_f32 v79, s42, v79
    v_mul_f32 v95, s42, v95
    v_cvt_pk_bf16_f32 v31, v79, v95
    buffer_store_dword v31, v15, s[20:23], 0 offen offset:2816 sc1
    s_endpgm
K1_PART:
    v_lshlrev_b32 v6, 2, v0
    v_mov_b32 v7, 0
    v_cmp_gt_u32 vcc, 512, v0
    s_mov_b64 exec, vcc
    ds_write_b32 v6, v7 offset:38400
    s_mov_b64 exec, s[46:47]
    v_mov_b32 v7, 1
    s_add_u32 s20, s18, 0
    s_addc_u32 s21, s19, 0
    s_waitcnt lgkmcnt(0)
    s_barrier
    s_mov_b32 s41, 0x06050400
    s_waitcnt vmcnt(3)
    v_mul_u32_u24 v24, 5369, v8
    v_lshrrev_b32 v24, 18, v24
    v_lshlrev_b32 v24, 2, v24
    ds_add_rtn_u32 v28, v24, v7 offset:38400
    v_mul_u32_u24 v25, 5369, v9
    v_lshrrev_b32 v25, 18, v25
    v_lshlrev_b32 v25, 2, v25
    ds_add_rtn_u32 v29, v25, v7 offset:38400
    v_mul_u32_u24 v26, 5369, v10
    v_lshrrev_b32 v26, 18, v26
    v_lshlrev_b32 v26, 2, v26
    ds_add_rtn_u32 v30, v26, v7 offset:38400
    v_mul_u32_u24 v27, 5369, v11
    v_lshrrev_b32 v27, 18, v27
    v_lshlrev_b32 v27, 2, v27
    ds_add_rtn_u32 v31, v27, v7 offset:38400
    v_lshlrev_b32 v8, 2, v8
    v_lshlrev_b32 v9, 2, v9
    v_lshlrev_b32 v10, 2, v10
    v_lshlrev_b32 v11, 2, v11
    s_mov_b64 exec, -1
    v_lshlrev_b32 v56, 4, v2
    s_waitcnt lgkmcnt(0)
    s_barrier
    ds_read_b128 v[60:63], v56 offset:38400
    s_waitcnt lgkmcnt(0)
    v_add_u32 v65, v60, v61
    v_add3_u32 v57, v65, v62, v63
    v_add3_u32 v58, v65, v62, v63
    s_nop 1
    v_add_u32_dpp v58, v58, v58 row_shr:1 row_mask:0xf bank_mask:0xf bound_ctrl:0
    s_nop 1
    v_add_u32_dpp v58, v58, v58 row_shr:2 row_mask:0xf bank_mask:0xf bound_ctrl:0
    s_nop 1
    v_add_u32_dpp v58, v58, v58 row_shr:4 row_mask:0xf bank_mask:0xf bound_ctrl:0
    s_nop 1
    v_add_u32_dpp v58, v58, v58 row_shr:8 row_mask:0xf bank_mask:0xf bound_ctrl:0
    s_nop 1
    v_add_u32_dpp v58, v58, v58 row_bcast:15 row_mask:0xa bank_mask:0xf
    s_nop 1
    v_add_u32_dpp v58, v58, v58 row_bcast:31 row_mask:0xc bank_mask:0xf
    v_sub_u32 v64, v58, v57
    v_add_u32 v66, v64, v65
    v_add_u32 v65, v64, v60
    v_add_u32 v67, v66, v62
    ds_write_b128 v56, v[64:67] offset:39424
    s_mov_b64 exec, s[46:47]
    ds_read_b32 v32, v24 offset:39424
    ds_read_b32 v33, v25 offset:39424
    ds_read_b32 v34, v26 offset:39424
    ds_read_b32 v35, v27 offset:39424
    s_waitcnt vmcnt(2)
    v_perm_b32 v12, v12, v8, s41
    v_perm_b32 v13, v13, v9, s41
    v_perm_b32 v14, v14, v10, s41
    v_perm_b32 v15, v15, v11, s41
    s_waitcnt vmcnt(0)
    s_waitcnt lgkmcnt(3)
    v_add_u32 v28, v28, v32
    v_mul_u32_u24 v28, 12, v28
    ds_write2_b32 v28, v16, v17 offset0:0 offset1:1
    ds_write_b32 v28, v12 offset:8
    s_waitcnt lgkmcnt(4)
    v_add_u32 v29, v29, v33
    v_mul_u32_u24 v29, 12, v29
    ds_write2_b32 v29, v18, v19 offset0:0 offset1:1
    ds_write_b32 v29, v13 offset:8
    s_waitcnt lgkmcnt(5)
    v_add_u32 v30, v30, v34
    v_mul_u32_u24 v30, 12, v30
    ds_write2_b32 v30, v20, v21 offset0:0 offset1:1
    ds_write_b32 v30, v14 offset:8
    s_waitcnt lgkmcnt(6)
    v_add_u32 v31, v31, v35
    v_mul_u32_u24 v31, 12, v31
    ds_write2_b32 v31, v22, v23 offset0:0 offset1:1
    ds_write_b32 v31, v15 offset:8
    s_mov_b64 exec, -1
    s_cmp_lg_u32 s3, 12
    s_cbranch_scc1 K1_NOTBL
    v_lshl_or_b32 v60, v60, 16, v64
    v_lshl_or_b32 v61, v61, 16, v65
    v_lshl_or_b32 v62, v62, 16, v66
    v_lshl_or_b32 v63, v63, 16, v67
    s_lshl_b32 s41, s36, 10
    s_add_u32 s41, s41, 11238912
    buffer_store_dwordx4 v[60:63], v56, s[20:23], s41 offen sc1
K1_NOTBL:
    s_mul_i32 s41, s36, 38400
    s_add_u32 s41, s41, 6438912
    v_add_u32 v4, s41, v3
    v_add_u32 v5, 12800, v4
    v_add_u32 v6, 25600, v4
    s_mov_b64 exec, s[46:47]
    s_waitcnt lgkmcnt(0)
    s_barrier
    ds_read_b128 v[8:11], v3 offset:0
    ds_read_b128 v[12:15], v3 offset:12800
    ds_read_b128 v[16:19], v3 offset:25600
    s_waitcnt lgkmcnt(2)
    buffer_store_dwordx4 v[8:11], v4, s[20:23], 0 offen sc1
    s_waitcnt lgkmcnt(1)
    buffer_store_dwordx4 v[12:15], v5, s[20:23], 0 offen sc1
    s_waitcnt lgkmcnt(0)
    buffer_store_dwordx4 v[16:19], v6, s[20:23], 0 offen sc1
    s_endpgm
K1_PACK:
    s_lshl_b32 s36, s36, 1
    s_add_u32 s36, s36, s3
    s_sub_u32 s36, s36, 13
    s_cmp_eq_u32 s3, 15
    s_cbranch_scc1 K1_TOUCH
    s_cmp_ge_u32 s36, 131
    s_cbranch_scc1 K1_END
    s_waitcnt lgkmcnt(0)
    s_add_u32 s20, s18, 0
    s_addc_u32 s21, s19, 0
    s_and_b32 s44, s36, 7
    s_bfe_u32 s45, s36, 0x30003
    s_lshl_b32 s39, s36, 10
    s_add_u32 s39, s39, 11366912
    v_lshlrev_b32 v5, 4, v2
    s_cmp_ge_u32 s36, 128
    s_cbranch_scc1 K1_PBE
    s_cmp_ge_u32 s36, 64
    s_cbranch_scc1 K1_PW2
    s_mov_b32 s24, s12
    s_and_b32 s25, s13, 0xffff
    s_mov_b32 s26, 133120
    s_lshr_b32 s37, s45, 1
    s_lshl_b32 s37, s37, 6
    s_and_b32 s38, s45, 1
    s_lshl_b32 s38, s38, 4
    s_add_u32 s37, s37, s38
    s_lshl_b32 s37, s37, 1
    s_lshl_b32 s38, s44, 13
    s_add_u32 s37, s37, s38
    s_add_u32 s37, s37, 65536
    v_and_b32 v3, 1, v2
    v_lshlrev_b32 v3, 6, v3
    v_bfe_u32 v4, v2, 1, 4
    v_lshl_add_u32 v3, v4, 1, v3
    v_lshrrev_b32 v4, 5, v2
    v_lshl_add_u32 v3, v4, 12, v3
    buffer_load_ushort v8, v3, s[24:27], s37 offen offset:0
    buffer_load_ushort v9, v3, s[24:27], s37 offen offset:512
    buffer_load_ushort v10, v3, s[24:27], s37 offen offset:1024
    buffer_load_ushort v11, v3, s[24:27], s37 offen offset:1536
    buffer_load_ushort v12, v3, s[24:27], s37 offen offset:2048
    buffer_load_ushort v13, v3, s[24:27], s37 offen offset:2560
    buffer_load_ushort v14, v3, s[24:27], s37 offen offset:3072
    buffer_load_ushort v15, v3, s[24:27], s37 offen offset:3584
K1_PACKST:
    s_waitcnt vmcnt(0)
    v_lshl_or_b32 v16, v9, 16, v8
    v_lshl_or_b32 v17, v11, 16, v10
    v_lshl_or_b32 v18, v13, 16, v12
    v_lshl_or_b32 v19, v15, 16, v14
    buffer_store_dwordx4 v[16:19], v5, s[20:23], s39 offen
    s_endpgm
K1_PW2:
    s_mov_b32 s24, s16
    s_and_b32 s25, s17, 0xffff
    s_mov_b32 s26, 65536
    s_lshr_b32 s37, s44, 1
    s_lshl_b32 s37, s37, 6
    s_and_b32 s38, s44, 1
    s_lshl_b32 s38, s38, 4
    s_add_u32 s37, s37, s38
    s_lshl_b32 s37, s37, 8
    s_lshr_b32 s38, s45, 1
    s_lshl_b32 s38, s38, 6
    s_add_u32 s37, s37, s38
    s_and_b32 s38, s45, 1
    s_lshl_b32 s38, s38, 1
    s_add_u32 s37, s37, s38
    s_add_u32 s38, s37, 8192
    v_and_b32 v3, 15, v2
    v_lshlrev_b32 v3, 2, v3
    v_lshrrev_b32 v4, 4, v2
    v_lshl_add_u32 v3, v4, 10, v3
    buffer_load_ushort v8, v3, s[24:27], s37 offen offset:0
    buffer_load_ushort v9, v3, s[24:27], s38 offen offset:0
    buffer_load_ushort v10, v3, s[24:27], s37 offen offset:256
    buffer_load_ushort v11, v3, s[24:27], s38 offen offset:256
    buffer_load_ushort v12, v3, s[24:27], s37 offen offset:512
    buffer_load_ushort v13, v3, s[24:27], s38 offen offset:512
    buffer_load_ushort v14, v3, s[24:27], s37 offen offset:768
    buffer_load_ushort v15, v3, s[24:27], s38 offen offset:768
    s_branch K1_PACKST
K1_PB1:
    v_lshrrev_b32 v3, 4, v2
    v_lshlrev_b32 v3, 7, v3
    v_and_b32 v4, 15, v2
    v_lshl_add_u32 v3, v4, 2, v3
    global_load_dword v8, v3, s[14:15]
    global_load_dword v9, v3, s[14:15] offset:64
    s_waitcnt vmcnt(0)
    v_lshlrev_b32 v16, 16, v8
    v_lshlrev_b32 v17, 16, v9
    v_and_b32 v18, 0xffff0000, v8
    v_and_b32 v19, 0xffff0000, v9
    v_mul_f32 v16, 0xbfb8aa3b, v16
    v_mul_f32 v17, 0xbfb8aa3b, v17
    v_mul_f32 v18, 0xbfb8aa3b, v18
    v_mul_f32 v19, 0xbfb8aa3b, v19
    buffer_store_dwordx4 v[16:19], v5, s[20:23], s39 offen
    s_endpgm
K1_PBE:
    s_cmp_eq_u32 s36, 130
    s_cbranch_scc1 K1_PB1
    s_mov_b32 s24, s12
    s_and_b32 s25, s13, 0xffff
    s_mov_b32 s26, 133120
    s_lshl_b32 s37, s44, 8
    s_add_u32 s37, s37, 131072
    v_and_b32 v3, 31, v2
    v_lshlrev_b32 v3, 1, v3
    v_lshrrev_b32 v4, 5, v2
    v_lshl_add_u32 v3, v4, 7, v3
    buffer_load_ushort v8, v3, s[24:27], s37 offen offset:0
    buffer_load_ushort v9, v3, s[24:27], s37 offen offset:512
    buffer_load_ushort v10, v3, s[24:27], s37 offen offset:1024
    buffer_load_ushort v11, v3, s[24:27], s37 offen offset:1536
    buffer_load_ushort v12, v3, s[24:27], s37 offen offset:64
    buffer_load_ushort v13, v3, s[24:27], s37 offen offset:576
    buffer_load_ushort v14, v3, s[24:27], s37 offen offset:1088
    buffer_load_ushort v15, v3, s[24:27], s37 offen offset:1600
    s_waitcnt vmcnt(0)
    v_lshlrev_b32 v8, 16, v8
    v_mul_f32 v8, 0xbfb8aa3b, v8
    v_lshlrev_b32 v9, 16, v9
    v_mul_f32 v9, 0xbfb8aa3b, v9
    v_lshlrev_b32 v10, 16, v10
    v_mul_f32 v10, 0xbfb8aa3b, v10
    v_lshlrev_b32 v11, 16, v11
    v_mul_f32 v11, 0xbfb8aa3b, v11
    v_lshlrev_b32 v12, 16, v12
    v_mul_f32 v12, 0xbfb8aa3b, v12
    v_lshlrev_b32 v13, 16, v13
    v_mul_f32 v13, 0xbfb8aa3b, v13
    v_lshlrev_b32 v14, 16, v14
    v_mul_f32 v14, 0xbfb8aa3b, v14
    v_lshlrev_b32 v15, 16, v15
    v_mul_f32 v15, 0xbfb8aa3b, v15
    v_cvt_pk_bf16_f32 v16, v8, v9
    v_cvt_pk_bf16_f32 v17, v10, v11
    v_cvt_pk_bf16_f32 v18, v12, v13
    v_cvt_pk_bf16_f32 v19, v14, v15
    buffer_store_dwordx4 v[16:19], v5, s[20:23], s39 offen
K1_END:
    s_endpgm
K1_TOUCH:
    s_sub_u32 s36, s2, 131
    s_mul_i32 s37, s36, 38400
    s_add_u32 s37, s37, 6438912
    v_lshlrev_b32 v3, 15, v2
    v_min_u32 v3, 38396, v3
    v_add_u32 v3, s37, v3
    s_waitcnt lgkmcnt(0)
    s_add_u32 s20, s18, 0
    s_addc_u32 s21, s19, 0
    s_mov_b64 exec, 7
    buffer_load_dword v4, v3, s[20:23], 0 offen
    s_mov_b64 exec, -1
    s_getpc_b64 s[24:25]
K1_PCREF:
    s_add_u32 s24, s24, main_kernel-K1_PCREF
    s_addc_u32 s25, s25, 0
    v_lshlrev_b32 v3, 6, v2
    global_load_dword v5, v3, s[24:25]
    v_add_u32 v3, 0x1000, v3
    global_load_dword v6, v3, s[24:25]
    v_add_u32 v3, 0x1000, v3
    global_load_dword v7, v3, s[24:25]
    s_waitcnt vmcnt(0)
    s_endpgm
.p2align 8
.globl main_kernel
.type main_kernel,@function
main_kernel:
    s_cmp_ge_u32 s2, 256
    s_cbranch_scc1 K3_END
    s_setprio 3
    s_load_dwordx2 s[12:13], s[0:1], 80
    s_load_dwordx2 s[4:5], s[0:1], 0
    s_load_dwordx4 s[8:11], s[0:1], 56
    v_lshrrev_b32 v1, 6, v0
    v_mov_b32 v125, v0
    v_readfirstlane_b32 s3, v1
    s_and_b32 s16, s2, 7
    s_lshl_b32 s16, s16, 5
    s_lshr_b32 s2, s2, 3
    s_or_b32 s2, s2, s16
    s_lshl_b32 s16, s2, 2
    s_add_u32 s16, s16, 11238912
    s_mul_i32 s17, s2, 399979
    s_add_u32 s17, s17, 8110
    s_add_u32 s19, s17, 399979
    s_lshr_b32 s39, s17, 13
    s_lshr_b32 s19, s19, 13
    s_lshl_b32 s17, s39, 8
    s_lshl_b32 s34, s19, 8
    s_lshl_b32 s26, s19, 8
    v_mul_u32_u24 v6, 10923, v125
    v_lshrrev_b32 v6, 16, v6
    v_mul_u32_u24 v15, 6, v6
    v_sub_u32 v15, v125, v15
    v_mul_u32_u24 v124, 3200, v6
    v_add_u32 v124, v124, v15
    v_lshl_add_u32 v3, v6, 10, s16
    v_lshl_add_u32 v4, v0, 4, s17
    v_cmp_gt_u32 vcc, 750, v0
    v_and_b32 v0, 63, v0
    v_lshlrev_b32 v0, 2, v0
    v_mov_b32 v126, 0
    s_mov_b32 s22, 23109120
    s_mov_b32 s23, 0x00020000
    s_mov_b32 s27, 0x00020000
    s_waitcnt lgkmcnt(0)
    s_add_u32 s20, s12, 0
    s_addc_u32 s21, s13, 0
    s_mov_b32 s24, s4
    s_and_b32 s25, s5, 0xffff
    s_mov_b64 exec, vcc
    s_cbranch_execz K3_NOTB
    buffer_load_dword v126, v3, s[20:23], 0 offen
K3_NOTB:
    s_mov_b64 exec, -1
    buffer_load_dwordx4 v[8:11], v4, s[24:27], 0 offen
    s_setprio 0
    s_lshl_b32 s14, s3, 10
    v_lshl_add_u32 v3, v0, 2, s14
    s_add_u32 s14, s14, 1024
    s_cmp_lt_u32 s3, 9
    s_cselect_b32 s15, 3200000, 0
    s_cselect_b32 s14, s14, 0
    v_lshl_add_u32 v2, v0, 2, s14
    v_pk_mov_b32 v[4:5], 0, 0
    v_pk_mov_b32 v[6:7], 0, 0
    ds_write_b128 v3, v[4:7] offset:38160
    ds_write_b128 v3, v[4:7] offset:54544
    v_mov_b32 v4, s15
    v_mov_b32 v5, s15
    v_mov_b32 v6, s15
    v_mov_b32 v7, s15
    ds_write_b128 v2, v[4:7]
    s_mov_b32 s96, s20
    s_or_b32 s97, s21, 0x40000
    s_add_u32 s98, s96, 3219456
    s_addc_u32 s99, s97, 0
    s_mov_b32 s31, 0x00800000
    s_mov_b32 s32, s10
    s_and_b32 s33, s11, 0xffff
    s_mov_b32 s35, 0x00020000
    s_mov_b32 s36, 0
    s_mov_b32 s37, 0
    s_mov_b32 s38, 0
    s_mov_b32 s55, 0
    s_mov_b32 s70, 0x43800000
    s_mov_b32 s71, 0x43800000
    s_and_b32 s59, s3, 3
    s_lshl_b32 s59, s59, 2
    s_lshr_b32 s14, s3, 2
    s_add_u32 s59, s59, s14
    s_lshl_b32 s39, s39, 2
    s_mov_b32 s19, 0
    v_lshrrev_b32 v12, 4, v125
    v_mul_u32_u24 v12, 272, v12
    v_and_b32 v7, 60, v0
    v_lshl_add_u32 v12, v7, 2, v12
    v_add_u32 v12, 126224, v12
    s_cmp_ge_u32 s3, 12
    s_cbranch_scc1 K3_QWAVE
    v_bfe_u32 v2, v0, 3, 1
    v_bfe_u32 v3, v0, 5, 2
    v_lshl_add_u32 v2, v3, 1, v2
    s_mov_b32 s72, 0x05050505
    s_mov_b32 s73, 0x50505050
    s_mov_b32 s74, 0x0a0a0a0a
    s_mov_b32 s75, 0xa0a0a0a0
    s_or_b64 s[76:77], s[72:73], s[74:75]
    v_lshlrev_b32 v4, 4, v2
    v_and_b32 v5, 4, v0
    v_lshlrev_b32 v5, 1, v5
    v_sub_u32 v4, v4, v5
    v_add_u32 v4, 38176, v4
    v_mov_b32 v5, 576
    v_mov_b32 v6, 0x80
    v_cndmask_b32 v14, 0, v6, s[76:77]
    v_cndmask_b32 v13, v5, v4, s[76:77]
    v_mov_b32 v3, 0x3f80
    s_mov_b32 s76, 0x0000000f
    s_mov_b32 s77, 0x000f0000
    v_cndmask_b32 v108, 0, v3, s[76:77]
    s_mov_b32 s78, 0x00000f00
    s_mov_b32 s79, 0x0f000000
    v_cndmask_b32 v109, 0, v3, s[78:79]
    s_mov_b32 s76, 0x000000f0
    s_mov_b32 s77, 0x00f00000
    v_cndmask_b32 v110, 0, v3, s[76:77]
    s_mov_b32 s78, 0x0000f000
    s_mov_b32 s79, 0xf0000000
    v_cndmask_b32 v111, 0, v3, s[78:79]
    v_bfe_u32 v3, v0, 2, 2
    v_mul_u32_u24 v112, 0x1111, v3
    v_pk_mov_b32 v[120:121], 0, 0
    v_mov_b32 v7, 0
    s_setprio 2
    s_waitcnt vmcnt(0)
    v_and_b32 v2, 0xffff, v126
    v_lshrrev_b32 v3, 16, v126
    v_add_u32 v2, v2, v124
    v_sub_u32 v3, v3, v15
    v_mul_u32_u24 v2, 12, v2
    v_add_u32 v2, 6438912, v2
    v_cmp_lt_i32 s[72:73], 0, v3
    v_cmp_lt_i32 s[74:75], 6, v3
    v_cmp_lt_i32 s[76:77], 12, v3
    v_cmp_lt_i32 s[78:79], 18, v3
    v_cmp_lt_i32 s[80:81], 24, v3
    v_cmp_lt_i32 s[82:83], 30, v3
    v_cmp_lt_i32 s[84:85], 36, v3
    s_mov_b64 exec, s[72:73]
    s_cbranch_execz K3_RLaX
    buffer_load_dwordx3 v[64:66], v2, s[20:23], 0 offen offset:0
    s_mov_b64 exec, s[74:75]
    s_cbranch_execz K3_RLaX
    buffer_load_dwordx3 v[68:70], v2, s[20:23], 0 offen offset:72
    s_mov_b64 exec, s[76:77]
    s_cbranch_execz K3_RLaX
    buffer_load_dwordx3 v[72:74], v2, s[20:23], 0 offen offset:144
    s_mov_b64 exec, s[78:79]
    s_cbranch_execz K3_RLaX
    buffer_load_dwordx3 v[76:78], v2, s[20:23], 0 offen offset:216
    s_mov_b64 exec, s[80:81]
    s_cbranch_execz K3_RLaX
    buffer_load_dwordx3 v[80:82], v2, s[20:23], 0 offen offset:288
    s_mov_b64 exec, s[82:83]
    s_cbranch_execz K3_RLaX
    buffer_load_dwordx3 v[84:86], v2, s[20:23], 0 offen offset:360
K3_RLaX:
    s_mov_b64 exec, -1
    ds_write_b128 v12, v[8:11]
    s_waitcnt lgkmcnt(0)
    s_barrier
K3_INSERT:
    v_mov_b32 v2, 1
    s_waitcnt vmcnt(0)
    s_mov_b64 exec, s[72:73]
    v_subrev_u32 v48, s39, v66
    v_and_b32 v48, 0xfc, v48
    ds_add_rtn_u32 v67, v48, v2 offset:0
    v_and_b32 v66, 0xffffff00, v66
    s_mov_b64 exec, s[74:75]
    v_subrev_u32 v49, s39, v70
    v_and_b32 v49, 0xfc, v49
    ds_add_rtn_u32 v71, v49, v2 offset:0
    v_and_b32 v70, 0xffffff00, v70
    s_mov_b64 exec, s[76:77]
    v_subrev_u32 v50, s39, v74
    v_and_b32 v50, 0xfc, v50
    ds_add_rtn_u32 v75, v50, v2 offset:0
    v_and_b32 v74, 0xffffff00, v74
    s_mov_b64 exec, s[78:79]
    s_cbranch_execz K3_I3
    v_subrev_u32 v51, s39, v78
    v_and_b32 v51, 0xfc, v51
    ds_add_rtn_u32 v79, v51, v2 offset:0
    v_and_b32 v78, 0xffffff00, v78
K3_I3:
    s_mov_b64 exec, s[80:81]
    s_cbranch_execz K3_I4
    v_subrev_u32 v52, s39, v82
    v_and_b32 v52, 0xfc, v52
    ds_add_rtn_u32 v83, v52, v2 offset:0
    v_and_b32 v82, 0xffffff00, v82
K3_I4:
    s_mov_b64 exec, s[82:83]
    s_cbranch_execz K3_I5
    v_subrev_u32 v53, s39, v86
    v_and_b32 v53, 0xfc, v53
    ds_add_rtn_u32 v87, v53, v2 offset:0
    v_and_b32 v86, 0xffffff00, v86
K3_I5:
    s_mov_b64 exec, -1
    s_lshl_b32 s14, s39, 6
    v_mov_b32 v6, s14
    v_lshlrev_b32 v5, 16, v0
    s_mov_b64 exec, 1
    buffer_load_dword v127, v6, s[32:35], 0 offen
    s_mov_b64 exec, 0x1ffffff
    buffer_load_dword v127, v5, s[20:23], 0 offen
    s_mov_b64 exec, -1
    s_waitcnt lgkmcnt(0)
    s_barrier
K3_SCAN:
    ds_read_b32 v10, v0 offset:0
    v_mul_u32_u24 v9, 5, v0
    v_lshrrev_b32 v9, 2, v9
    s_mov_b32 s18, 0
    s_waitcnt lgkmcnt(0)
    v_mov_b32 v6, v10
    s_nop 1
    v_add_u32_dpp v6, v6, v6 row_shr:1 row_mask:0xf bank_mask:0xf bound_ctrl:0
    s_nop 1
    v_add_u32_dpp v6, v6, v6 row_shr:2 row_mask:0xf bank_mask:0xf bound_ctrl:0
    s_nop 1
    v_add_u32_dpp v6, v6, v6 row_shr:4 row_mask:0xf bank_mask:0xf bound_ctrl:0
    s_nop 1
    v_add_u32_dpp v6, v6, v6 row_shr:8 row_mask:0xf bank_mask:0xf bound_ctrl:0
    s_nop 1
    v_add_u32_dpp v6, v6, v6 row_bcast:15 row_mask:0xa bank_mask:0xf
    s_nop 1
    v_add_u32_dpp v6, v6, v6 row_bcast:31 row_mask:0xc bank_mask:0xf
    v_sub_u32 v5, v6, v10
    v_readlane_b32 s16, v6, 63
    v_add3_u32 v4, v5, v6, v9
    v_cvt_f32_u32 v4, v4
    s_cmp_gt_u32 s16, 1880
    s_cbranch_scc1 K3_CLAMP
K3_CLAMPED:
    s_lshl_b32 s17, s16, 1
    s_add_u32 s17, s17, 245
    v_cvt_f32_u32 v3, s17
    v_rcp_f32 v3, v3
    v_mul_f32 v4, 0x41800000, v4
    v_mul_f32 v4, v4, v3
    v_cvt_u32_f32 v4, v4
    v_min_u32 v4, 15, v4
    s_nop 1
    v_mov_b32_dpp v3, v4 wave_shr:1 row_mask:0xf bank_mask:0xf bound_ctrl:0
    v_cmp_ne_u32 vcc, v3, v4
    v_lshl_add_u32 v8, v4, 3, v5
    s_nop 0
    v_cndmask_b32 v3, 0, v5, vcc
    s_nop 1
    v_max_u32_dpp v3, v3, v3 row_shr:1 row_mask:0xf bank_mask:0xf bound_ctrl:0
    s_nop 1
    v_max_u32_dpp v3, v3, v3 row_shr:2 row_mask:0xf bank_mask:0xf bound_ctrl:0
    s_nop 1
    v_max_u32_dpp v3, v3, v3 row_shr:4 row_mask:0xf bank_mask:0xf bound_ctrl:0
    s_nop 1
    v_max_u32_dpp v3, v3, v3 row_shr:8 row_mask:0xf bank_mask:0xf bound_ctrl:0
    s_nop 1
    v_max_u32_dpp v3, v3, v3 row_bcast:15 row_mask:0xa bank_mask:0xf
    s_nop 1
    v_max_u32_dpp v3, v3, v3 row_bcast:31 row_mask:0xc bank_mask:0xf
    v_sub_u32 v3, 0, v3
    v_and_b32 v3, 7, v3
    v_add_u32 v8, v8, v3
    ds_bpermute_b32 v56, v48, v8
    ds_bpermute_b32 v57, v49, v8
    ds_bpermute_b32 v58, v50, v8
    ds_bpermute_b32 v59, v51, v8
    s_or_b64 s[16:17], s[80:81], s[82:83]
    s_cbranch_scc0 K3_BPX
    ds_bpermute_b32 v60, v52, v8
    ds_bpermute_b32 v61, v53, v8
K3_BPX:
    v_cmp_ne_u32 s[86:87], 0, v10
    v_cmp_eq_u32 s[48:49], s59, v4
    s_mov_b64 s[28:29], s[96:97]
    s_mov_b32 s30, 3219456
    s_and_b64 s[48:49], s[48:49], s[86:87]
    s_ff1_i32_b64 s62, s[48:49]
    s_max_i32 s62, s62, 0
    v_readlane_b32 s53, v8, s62
    s_lshl_b32 s62, s53, 2
    s_and_b32 s62, s62, -32
    s_add_u32 s62, s62, 1024
    s_lshr_b32 s53, s53, 3
    v_mov_b32 v12, s62
    s_or_b32 s62, s19, s18
    s_cbranch_scc1 K3_LIMIT
    s_waitcnt lgkmcnt(0)
    s_mov_b64 exec, s[72:73]
    v_add_lshl_u32 v56, v56, v67, 2
    v_lshlrev_b32 v48, 2, v56
    ds_write_b32 v56, v66 offset:1024
    ds_write_b64 v48, v[64:65] offset:38176
    s_mov_b64 exec, s[74:75]
    v_add_lshl_u32 v57, v57, v71, 2
    v_lshlrev_b32 v49, 2, v57
    ds_write_b32 v57, v70 offset:1024
    ds_write_b64 v49, v[68:69] offset:38176
    s_mov_b64 exec, s[76:77]
    v_add_lshl_u32 v58, v58, v75, 2
    v_lshlrev_b32 v50, 2, v58
    ds_write_b32 v58, v74 offset:1024
    ds_write_b64 v50, v[72:73] offset:38176
    s_mov_b64 exec, s[78:79]
    s_cbranch_execz K3_J3
    v_add_lshl_u32 v59, v59, v79, 2
    v_lshlrev_b32 v51, 2, v59
    ds_write_b32 v59, v78 offset:1024
    ds_write_b64 v51, v[76:77] offset:38176
K3_J3:
    s_mov_b64 exec, s[80:81]
    s_cbranch_execz K3_J4
    v_add_lshl_u32 v60, v60, v83, 2
    v_lshlrev_b32 v52, 2, v60
    ds_write_b32 v60, v82 offset:1024
    ds_write_b64 v52, v[80:81] offset:38176
K3_J4:
    s_mov_b64 exec, s[82:83]
    s_cbranch_execz K3_J5
    v_add_lshl_u32 v61, v61, v87, 2
    v_lshlrev_b32 v53, 2, v61
    ds_write_b32 v61, v86 offset:1024
    ds_write_b64 v53, v[84:85] offset:38176
K3_J5:
K3_LIMITED:
    s_mov_b64 exec, -1
    s_waitcnt lgkmcnt(0)
    s_barrier
K3_PLACED:
    ds_read_b128 v[64:67], v12 offset:0
    ds_read_b128 v[68:71], v12 offset:16
    ds_read_b128 v[72:75], v12 offset:32
    ds_read_b128 v[76:79], v12 offset:48
    ds_read_b128 v[80:83], v12 offset:64
    ds_read_b128 v[84:87], v12 offset:80
    ds_read_b128 v[88:91], v12 offset:96
    ds_read_b128 v[92:95], v12 offset:112
    ds_read_b128 v[96:99], v12 offset:128
    ds_read_b128 v[100:103], v12 offset:144
    v_mad_u32_u24 v13, v14, s53, v13
    v_lshlrev_b32 v124, 2, v0
    s_waitcnt lgkmcnt(8)
    buffer_load_dword v64, v64, s[28:31], 0 offen
    buffer_load_dword v65, v65, s[28:31], 0 offen
    buffer_load_dword v66, v66, s[28:31], 0 offen
    buffer_load_dword v67, v67, s[28:31], 0 offen
    buffer_load_dword v68, v68, s[28:31], 0 offen
    buffer_load_dword v69, v69, s[28:31], 0 offen
    buffer_load_dword v70, v70, s[28:31], 0 offen
    buffer_load_dword v71, v71, s[28:31], 0 offen
    s_waitcnt lgkmcnt(6)
    buffer_load_dword v72, v72, s[28:31], 0 offen
    buffer_load_dword v73, v73, s[28:31], 0 offen
    buffer_load_dword v74, v74, s[28:31], 0 offen
    buffer_load_dword v75, v75, s[28:31], 0 offen
    buffer_load_dword v76, v76, s[28:31], 0 offen
    buffer_load_dword v77, v77, s[28:31], 0 offen
    buffer_load_dword v78, v78, s[28:31], 0 offen
    buffer_load_dword v79, v79, s[28:31], 0 offen
    ds_read2_b64 v[104:107], v13 offset0:0 offset1:1
    ds_read_b128 v[116:119], v124 offset:36112
    ds_write_b32 v0, v10 offset:320
    s_mov_b32 s19, 0
    s_bcnt1_i32_b64 s13, s[86:87]
    s_lshl_b32 s13, s13, 2
    s_add_u32 s13, s13, s39
    s_lshl_b32 s13, s13, 6
    s_sub_u32 s13, s34, s13
    s_cmp_eq_u64 s[84:85], 0
    s_cbranch_scc1 L_flag_1
    v_mov_b32 v6, 0
    v_mov_b32 v7, 1
    ds_write_b32 v6, v7 offset:260
L_flag_1:
    s_xor_b32 s62, s59, 4
    v_cmp_eq_u32 s[50:51], s62, v4
    v_add3_u32 v1, v8, v10, -1
    v_cmp_gt_u32 vcc, 8, v10
    s_and_b64 s[50:51], s[50:51], s[86:87]
    s_flbit_i32_b64 s62, s[48:49]
    s_xor_b32 s62, s62, 63
    s_and_b32 s62, s62, 63
    v_readlane_b32 s52, v1, s62
    s_ff1_i32_b64 s62, s[50:51]
    s_max_i32 s62, s62, 0
    v_readlane_b32 s4, v8, s62
    s_flbit_i32_b64 s62, s[50:51]
    s_xor_b32 s62, s62, 63
    s_and_b32 s62, s62, 63
    v_readlane_b32 s5, v1, s62
    v_pk_mov_b32 v[2:3], 0, 0
    v_pk_mov_b32 v[4:5], 1.0, 1.0
    s_mov_b64 s[100:101], s[96:97]
    s_mov_b32 s46, 71952
    s_mov_b32 s47, 0
    s_mov_b32 s45, 4
    s_or_b64 s[82:83], s[48:49], s[50:51]
    s_and_b64 s[82:83], s[82:83], vcc
    s_cbranch_scc1 K3_SIMPLE
    s_cmp_eq_u64 s[48:49], 0
    s_cbranch_scc1 K3_SIMPLE
    s_cmp_eq_u64 s[50:51], 0
    s_cbranch_scc1 K3_SIMPLE
    s_cmp_lg_u32 s37, 0
    s_cbranch_scc1 K3_SIMPLE
    s_lshr_b32 s52, s52, 3
    s_lshr_b32 s4, s4, 3
    s_lshr_b32 s5, s5, 3
    s_sub_u32 s5, s5, s4
    s_add_u32 s5, s5, 1
    s_sub_u32 s42, s52, s53
    s_add_u32 s42, s42, 1
    s_min_u32 s62, s42, s5
    s_cmp_le_u32 s62, 4
    s_cbranch_scc1 K3_SIMPLE
    s_sub_u32 s7, s4, s52
    s_sub_u32 s7, s7, 1
    s_lshl_b32 s54, s7, 5
    s_ff1_i32_b64 s62, s[48:49]
    s_bitset0_b64 s[48:49], s62
    v_readlane_b32 s63, v1, s62
    s_mul_i32 s44, s62, 528
    s_mul_i32 s62, s62, 1024
    s_add_u32 s62, s62, s46
    v_lshl_add_u32 v124, v0, 1, s62
    ds_read2_b64 v[48:51], v124 offset0:0 offset1:0
    ds_read2_b64 v[52:55], v124 offset0:0 offset1:0
    ds_read2_b64 v[56:59], v124 offset0:0 offset1:0
    ds_read2_b64 v[60:63], v124 offset0:0 offset1:0
    s_and_b32 s43, s63, 7
    s_lshr_b32 s41, s63, 3
    s_sub_u32 s41, s52, s41
    s_sub_u32 s61, s42, s41
    s_max_i32 s62, s41, s45
    s_sub_u32 s63, s42, 8
    s_max_i32 s62, s62, s63
    s_sub_u32 s40, s42, s62
    s_sub_u32 s40, s40, 1
    s_mov_b32 s42, s62
    v_add_u32 v12, 64, v12
    v_mad_i32_i24 v13, v14, -2, v13
    s_waitcnt vmcnt(8) lgkmcnt(0)
    s_setprio 3
    v_mfma_f32_32x32x16_bf16 v[16:31], v[104:107], v[116:119], v[48:63]
    v_smfmac_f32_32x32x32_bf16 v[16:31], v[108:111], v[64:71], v112
    buffer_load_dword v80, v80, s[28:31], 0 offen
    buffer_load_dword v81, v81, s[28:31], 0 offen
    buffer_load_dword v82, v82, s[28:31], 0 offen
    buffer_load_dword v83, v83, s[28:31], 0 offen
    buffer_load_dword v84, v84, s[28:31], 0 offen
    buffer_load_dword v85, v85, s[28:31], 0 offen
    buffer_load_dword v86, v86, s[28:31], 0 offen
    buffer_load_dword v87, v87, s[28:31], 0 offen
    buffer_load_dword v88, v88, s[28:31], 0 offen
    buffer_load_dword v89, v89, s[28:31], 0 offen
    buffer_load_dword v90, v90, s[28:31], 0 offen
    buffer_load_dword v91, v91, s[28:31], 0 offen
    buffer_load_dword v92, v92, s[28:31], 0 offen
    buffer_load_dword v93, v93, s[28:31], 0 offen
    buffer_load_dword v94, v94, s[28:31], 0 offen
    buffer_load_dword v95, v95, s[28:31], 0 offen
    s_sub_u32 s40, s40, 1
    s_cbranch_scc0 K3_PC
    s_call_b64 s[66:67], K3_R
K3_PC:
    ds_read2_b64 v[104:107], v13 offset0:48 offset1:49
    buffer_load_dword v64, v96, s[28:31], 0 offen
    buffer_load_dword v65, v97, s[28:31], 0 offen
    buffer_load_dword v66, v98, s[28:31], 0 offen
    buffer_load_dword v67, v99, s[28:31], 0 offen
    buffer_load_dword v68, v100, s[28:31], 0 offen
    buffer_load_dword v69, v101, s[28:31], 0 offen
    buffer_load_dword v70, v102, s[28:31], 0 offen
    buffer_load_dword v71, v103, s[28:31], 0 offen
    ds_read_b128 v[96:99], v12 offset:96
    ds_read_b128 v[100:103], v12 offset:112
    v_add_u32 v12, 128, v12
    v_lshl_add_u32 v13, v14, 2, v13
    s_cbranch_scc1 K3_B0
    s_branch K3_F0
.p2align 6
    s_nop 0
K3_F0:
    s_waitcnt vmcnt(24) lgkmcnt(2)
    v_mfma_f32_32x32x16_bf16 v[32:47], v[104:107], v[116:119], v[48:63]
    v_exp_f32 v104, v16
    v_exp_f32 v105, v17
    v_exp_f32 v106, v18
    v_exp_f32 v107, v19
    v_smfmac_f32_32x32x32_bf16 v[32:47], v[108:111], v[72:79], v112
    v_exp_f32 v8, v20
    v_exp_f32 v9, v21
    v_exp_f32 v10, v22
    v_exp_f32 v11, v23
    s_waitcnt lgkmcnt(0)
    s_mov_b64 s[28:29], s[100:101]
    s_sub_u32 s40, s40, 1
    s_cbranch_scc1 K3_FR0
K3_FC0:
    v_exp_f32 v72, v24
    v_exp_f32 v73, v25
    v_exp_f32 v74, v26
    v_exp_f32 v75, v27
    v_exp_f32 v76, v28
    v_exp_f32 v77, v29
    v_exp_f32 v78, v30
    v_exp_f32 v79, v31
    v_pk_fma_f32 v[6:7], v[16:17], v[4:5], v[2:3]
    v_pk_fma_f32 v[4:5], v[4:5], v[104:105], v[4:5]
    v_pk_fma_f32 v[2:3], v[2:3], v[104:105], v[6:7]
    v_pk_fma_f32 v[6:7], v[18:19], v[4:5], v[2:3]
    v_pk_fma_f32 v[4:5], v[4:5], v[106:107], v[4:5]
    v_pk_fma_f32 v[2:3], v[2:3], v[106:107], v[6:7]
    ds_read2_b64 v[104:107], v13 offset0:0 offset1:1
    v_pk_fma_f32 v[6:7], v[20:21], v[4:5], v[2:3]
    v_pk_fma_f32 v[4:5], v[4:5], v[8:9], v[4:5]
    v_pk_fma_f32 v[2:3], v[2:3], v[8:9], v[6:7]
    v_pk_fma_f32 v[6:7], v[22:23], v[4:5], v[2:3]
    v_pk_fma_f32 v[4:5], v[4:5], v[10:11], v[4:5]
    v_pk_fma_f32 v[2:3], v[2:3], v[10:11], v[6:7]
    v_pk_fma_f32 v[6:7], v[24:25], v[4:5], v[2:3]
    v_pk_fma_f32 v[4:5], v[4:5], v[72:73], v[4:5]
    v_pk_fma_f32 v[2:3], v[2:3], v[72:73], v[6:7]
    v_pk_fma_f32 v[6:7], v[26:27], v[4:5], v[2:3]
    v_pk_fma_f32 v[4:5], v[4:5], v[74:75], v[4:5]
    v_pk_fma_f32 v[2:3], v[2:3], v[74:75], v[6:7]
    v_pk_fma_f32 v[6:7], v[28:29], v[4:5], v[2:3]
    v_pk_fma_f32 v[4:5], v[4:5], v[76:77], v[4:5]
    v_pk_fma_f32 v[2:3], v[2:3], v[76:77], v[6:7]
    v_pk_fma_f32 v[6:7], v[30:31], v[4:5], v[2:3]
    v_pk_fma_f32 v[4:5], v[4:5], v[78:79], v[4:5]
    v_pk_fma_f32 v[2:3], v[2:3], v[78:79], v[6:7]
    buffer_load_dword v72, v96, s[28:31], 0 offen
    buffer_load_dword v73, v97, s[28:31], 0 offen
    buffer_load_dword v74, v98, s[28:31], 0 offen
    buffer_load_dword v75, v99, s[28:31], 0 offen
    buffer_load_dword v76, v100, s[28:31], 0 offen
    buffer_load_dword v77, v101, s[28:31], 0 offen
    buffer_load_dword v78, v102, s[28:31], 0 offen
    buffer_load_dword v79, v103, s[28:31], 0 offen
    ds_read_b128 v[96:99], v12 offset:0
    ds_read_b128 v[100:103], v12 offset:16
    s_cbranch_scc1 K3_B1
K3_F1:
    s_waitcnt vmcnt(24) lgkmcnt(2)
    v_mfma_f32_32x32x16_bf16 v[16:31], v[104:107], v[116:119], v[48:63]
    v_exp_f32 v104, v32
    v_exp_f32 v105, v33
    v_exp_f32 v106, v34
    v_exp_f32 v107, v35
    v_smfmac_f32_32x32x32_bf16 v[16:31], v[108:111], v[80:87], v112
    v_exp_f32 v8, v36
    v_exp_f32 v9, v37
    v_exp_f32 v10, v38
    v_exp_f32 v11, v39
    s_waitcnt lgkmcnt(0)
    s_mov_b64 s[28:29], s[100:101]
    s_sub_u32 s40, s40, 1
    s_cbranch_scc1 K3_FR1
K3_FC1:
    v_exp_f32 v80, v40
    v_exp_f32 v81, v41
    v_exp_f32 v82, v42
    v_exp_f32 v83, v43
    v_exp_f32 v84, v44
    v_exp_f32 v85, v45
    v_exp_f32 v86, v46
    v_exp_f32 v87, v47
    v_pk_fma_f32 v[6:7], v[32:33], v[4:5], v[2:3]
    v_pk_fma_f32 v[4:5], v[4:5], v[104:105], v[4:5]
    v_pk_fma_f32 v[2:3], v[2:3], v[104:105], v[6:7]
    v_pk_fma_f32 v[6:7], v[34:35], v[4:5], v[2:3]
    v_pk_fma_f32 v[4:5], v[4:5], v[106:107], v[4:5]
    v_pk_fma_f32 v[2:3], v[2:3], v[106:107], v[6:7]
    ds_read2_b64 v[104:107], v13 offset0:16 offset1:17
    v_pk_fma_f32 v[6:7], v[36:37], v[4:5], v[2:3]
    v_pk_fma_f32 v[4:5], v[4:5], v[8:9], v[4:5]
    v_pk_fma_f32 v[2:3], v[2:3], v[8:9], v[6:7]
    v_pk_fma_f32 v[6:7], v[38:39], v[4:5], v[2:3]
    v_pk_fma_f32 v[4:5], v[4:5], v[10:11], v[4:5]
    v_pk_fma_f32 v[2:3], v[2:3], v[10:11], v[6:7]
    v_pk_fma_f32 v[6:7], v[40:41], v[4:5], v[2:3]
    v_pk_fma_f32 v[4:5], v[4:5], v[80:81], v[4:5]
    v_pk_fma_f32 v[2:3], v[2:3], v[80:81], v[6:7]
    v_pk_fma_f32 v[6:7], v[42:43], v[4:5], v[2:3]
    v_pk_fma_f32 v[4:5], v[4:5], v[82:83], v[4:5]
    v_pk_fma_f32 v[2:3], v[2:3], v[82:83], v[6:7]
    v_pk_fma_f32 v[6:7], v[44:45], v[4:5], v[2:3]
    v_pk_fma_f32 v[4:5], v[4:5], v[84:85], v[4:5]
    v_pk_fma_f32 v[2:3], v[2:3], v[84:85], v[6:7]
    v_pk_fma_f32 v[6:7], v[46:47], v[4:5], v[2:3]
    v_pk_fma_f32 v[4:5], v[4:5], v[86:87], v[4:5]
    v_pk_fma_f32 v[2:3], v[2:3], v[86:87], v[6:7]
    buffer_load_dword v80, v96, s[28:31], 0 offen
    buffer_load_dword v81, v97, s[28:31], 0 offen
    buffer_load_dword v82, v98, s[28:31], 0 offen
    buffer_load_dword v83, v99, s[28:31], 0 offen
    buffer_load_dword v84, v100, s[28:31], 0 offen
    buffer_load_dword v85, v101, s[28:31], 0 offen
    buffer_load_dword v86, v102, s[28:31], 0 offen
    buffer_load_dword v87, v103, s[28:31], 0 offen
    ds_read_b128 v[96:99], v12 offset:32
    ds_read_b128 v[100:103], v12 offset:48
    s_cbranch_scc1 K3_B2
K3_F2:
    s_waitcnt vmcnt(24) lgkmcnt(2)
    v_mfma_f32_32x32x16_bf16 v[32:47], v[104:107], v[116:119], v[48:63]
    v_exp_f32 v104, v16
    v_exp_f32 v105, v17
    v_exp_f32 v106, v18
    v_exp_f32 v107, v19
    v_smfmac_f32_32x32x32_bf16 v[32:47], v[108:111], v[88:95], v112
    v_exp_f32 v8, v20
    v_exp_f32 v9, v21
    v_exp_f32 v10, v22
    v_exp_f32 v11, v23
    s_waitcnt lgkmcnt(0)
    s_mov_b64 s[28:29], s[100:101]
    s_sub_u32 s40, s40, 1
    s_cbranch_scc1 K3_FR2
K3_FC2:
    v_exp_f32 v88, v24
    v_exp_f32 v89, v25
    v_exp_f32 v90, v26
    v_exp_f32 v91, v27
    v_exp_f32 v92, v28
    v_exp_f32 v93, v29
    v_exp_f32 v94, v30
    v_exp_f32 v95, v31
    v_pk_fma_f32 v[6:7], v[16:17], v[4:5], v[2:3]
    v_pk_fma_f32 v[4:5], v[4:5], v[104:105], v[4:5]
    v_pk_fma_f32 v[2:3], v[2:3], v[104:105], v[6:7]
    v_pk_fma_f32 v[6:7], v[18:19], v[4:5], v[2:3]
    v_pk_fma_f32 v[4:5], v[4:5], v[106:107], v[4:5]
    v_pk_fma_f32 v[2:3], v[2:3], v[106:107], v[6:7]
    ds_read2_b64 v[104:107], v13 offset0:32 offset1:33
    v_pk_fma_f32 v[6:7], v[20:21], v[4:5], v[2:3]
    v_pk_fma_f32 v[4:5], v[4:5], v[8:9], v[4:5]
    v_pk_fma_f32 v[2:3], v[2:3], v[8:9], v[6:7]
    v_pk_fma_f32 v[6:7], v[22:23], v[4:5], v[2:3]
    v_pk_fma_f32 v[4:5], v[4:5], v[10:11], v[4:5]
    v_pk_fma_f32 v[2:3], v[2:3], v[10:11], v[6:7]
    v_pk_fma_f32 v[6:7], v[24:25], v[4:5], v[2:3]
    v_pk_fma_f32 v[4:5], v[4:5], v[88:89], v[4:5]
    v_pk_fma_f32 v[2:3], v[2:3], v[88:89], v[6:7]
    v_pk_fma_f32 v[6:7], v[26:27], v[4:5], v[2:3]
    v_pk_fma_f32 v[4:5], v[4:5], v[90:91], v[4:5]
    v_pk_fma_f32 v[2:3], v[2:3], v[90:91], v[6:7]
    v_pk_fma_f32 v[6:7], v[28:29], v[4:5], v[2:3]
    v_pk_fma_f32 v[4:5], v[4:5], v[92:93], v[4:5]
    v_pk_fma_f32 v[2:3], v[2:3], v[92:93], v[6:7]
    v_pk_fma_f32 v[6:7], v[30:31], v[4:5], v[2:3]
    v_pk_fma_f32 v[4:5], v[4:5], v[94:95], v[4:5]
    v_pk_fma_f32 v[2:3], v[2:3], v[94:95], v[6:7]
    buffer_load_dword v88, v96, s[28:31], 0 offen
    buffer_load_dword v89, v97, s[28:31], 0 offen
    buffer_load_dword v90, v98, s[28:31], 0 offen
    buffer_load_dword v91, v99, s[28:31], 0 offen
    buffer_load_dword v92, v100, s[28:31], 0 offen
    buffer_load_dword v93, v101, s[28:31], 0 offen
    buffer_load_dword v94, v102, s[28:31], 0 offen
    buffer_load_dword v95, v103, s[28:31], 0 offen
    ds_read_b128 v[96:99], v12 offset:64
    ds_read_b128 v[100:103], v12 offset:80
    s_cbranch_scc1 K3_B3
K3_F3:
    s_waitcnt vmcnt(24) lgkmcnt(2)
    v_mfma_f32_32x32x16_bf16 v[16:31], v[104:107], v[116:119], v[48:63]
    v_exp_f32 v104, v32
    v_exp_f32 v105, v33
    v_exp_f32 v106, v34
    v_exp_f32 v107, v35
    v_smfmac_f32_32x32x32_bf16 v[16:31], v[108:111], v[64:71], v112
    v_exp_f32 v8, v36
    v_exp_f32 v9, v37
    v_exp_f32 v10, v38
    v_exp_f32 v11, v39
    s_waitcnt lgkmcnt(0)
    s_mov_b64 s[28:29], s[100:101]
    s_sub_u32 s40, s40, 1
    s_cbranch_scc1 K3_FR3
K3_FC3:
    v_exp_f32 v64, v40
    v_exp_f32 v65, v41
    v_exp_f32 v66, v42
    v_exp_f32 v67, v43
    v_exp_f32 v68, v44
    v_exp_f32 v69, v45
    v_exp_f32 v70, v46
    v_exp_f32 v71, v47
    v_pk_fma_f32 v[6:7], v[32:33], v[4:5], v[2:3]
    v_pk_fma_f32 v[4:5], v[4:5], v[104:105], v[4:5]
    v_pk_fma_f32 v[2:3], v[2:3], v[104:105], v[6:7]
    v_pk_fma_f32 v[6:7], v[34:35], v[4:5], v[2:3]
    v_pk_fma_f32 v[4:5], v[4:5], v[106:107], v[4:5]
    v_pk_fma_f32 v[2:3], v[2:3], v[106:107], v[6:7]
    ds_read2_b64 v[104:107], v13 offset0:48 offset1:49
    v_pk_fma_f32 v[6:7], v[36:37], v[4:5], v[2:3]
    v_pk_fma_f32 v[4:5], v[4:5], v[8:9], v[4:5]
    v_pk_fma_f32 v[2:3], v[2:3], v[8:9], v[6:7]
    v_pk_fma_f32 v[6:7], v[38:39], v[4:5], v[2:3]
    v_pk_fma_f32 v[4:5], v[4:5], v[10:11], v[4:5]
    v_pk_fma_f32 v[2:3], v[2:3], v[10:11], v[6:7]
    v_pk_fma_f32 v[6:7], v[40:41], v[4:5], v[2:3]
    v_pk_fma_f32 v[4:5], v[4:5], v[64:65], v[4:5]
    v_pk_fma_f32 v[2:3], v[2:3], v[64:65], v[6:7]
    v_pk_fma_f32 v[6:7], v[42:43], v[4:5], v[2:3]
    v_pk_fma_f32 v[4:5], v[4:5], v[66:67], v[4:5]
    v_pk_fma_f32 v[2:3], v[2:3], v[66:67], v[6:7]
    v_pk_fma_f32 v[6:7], v[44:45], v[4:5], v[2:3]
    v_pk_fma_f32 v[4:5], v[4:5], v[68:69], v[4:5]
    v_pk_fma_f32 v[2:3], v[2:3], v[68:69], v[6:7]
    v_pk_fma_f32 v[6:7], v[46:47], v[4:5], v[2:3]
    v_pk_fma_f32 v[4:5], v[4:5], v[70:71], v[4:5]
    v_pk_fma_f32 v[2:3], v[2:3], v[70:71], v[6:7]
    buffer_load_dword v64, v96, s[28:31], 0 offen
    buffer_load_dword v65, v97, s[28:31], 0 offen
    buffer_load_dword v66, v98, s[28:31], 0 offen
    buffer_load_dword v67, v99, s[28:31], 0 offen
    buffer_load_dword v68, v100, s[28:31], 0 offen
    buffer_load_dword v69, v101, s[28:31], 0 offen
    buffer_load_dword v70, v102, s[28:31], 0 offen
    buffer_load_dword v71, v103, s[28:31], 0 offen
    ds_read_b128 v[96:99], v12 offset:96
    ds_read_b128 v[100:103], v12 offset:112
    v_add_u32 v12, 128, v12
    v_lshl_add_u32 v13, v14, 2, v13
    s_cbranch_scc1 K3_B0
    s_branch K3_F0
.p2align 3
K3_FR0:
    s_call_b64 s[66:67], K3_R
    s_branch K3_FC0
K3_B0:
    s_getpc_b64 s[68:69]
    s_add_u32 s68, s68, s57
    s_addc_u32 s69, s69, 0
    s_waitcnt vmcnt(24) lgkmcnt(0)
    v_pk_add_f32 v[6:7], v[48:49], v[122:123] neg_lo:[0,1] neg_hi:[0,1]
    s_cmp_lg_u32 s6, 0
    s_setpc_b64 s[68:69]
    v_pk_add_f32 v[18:19], v[18:19], v[6:7]
    v_pk_add_f32 v[20:21], v[20:21], v[6:7]
    v_pk_add_f32 v[22:23], v[22:23], v[6:7]
    v_pk_add_f32 v[24:25], v[24:25], v[6:7]
    v_pk_add_f32 v[26:27], v[26:27], v[6:7]
    v_pk_add_f32 v[28:29], v[28:29], v[6:7]
    v_pk_add_f32 v[30:31], v[30:31], v[6:7]
    v_mfma_f32_32x32x16_bf16 v[32:47], v[104:107], v[116:119], v[48:63]
    v_exp_f32 v104, v16
    v_exp_f32 v105, v17
    v_exp_f32 v106, v18
    v_exp_f32 v107, v19
    v_smfmac_f32_32x32x32_bf16 v[32:47], v[108:111], v[72:79], v112
    v_exp_f32 v8, v20
    v_exp_f32 v9, v21
    v_exp_f32 v10, v22
    v_exp_f32 v11, v23
    s_cbranch_scc1 K3_BS0
    v_exp_f32 v72, v24
    v_exp_f32 v73, v25
    v_exp_f32 v74, v26
    v_exp_f32 v75, v27
    v_exp_f32 v76, v28
    v_exp_f32 v77, v29
    v_exp_f32 v78, v30
    v_exp_f32 v79, v31
K3_BS0:
    s_mov_b64 s[28:29], s[100:101]
    s_getpc_b64 s[68:69]
    s_add_u32 s68, s68, s58
    s_addc_u32 s69, s69, 0
    s_setpc_b64 s[68:69]
    v_pk_fma_f32 v[6:7], v[30:31], v[4:5], v[2:3]
    v_pk_fma_f32 v[4:5], v[4:5], v[78:79], v[4:5]
    v_pk_fma_f32 v[2:3], v[2:3], v[78:79], v[6:7]
    v_pk_fma_f32 v[6:7], v[28:29], v[4:5], v[2:3]
    v_pk_fma_f32 v[4:5], v[4:5], v[76:77], v[4:5]
    v_pk_fma_f32 v[2:3], v[2:3], v[76:77], v[6:7]
    v_pk_fma_f32 v[6:7], v[26:27], v[4:5], v[2:3]
    v_pk_fma_f32 v[4:5], v[4:5], v[74:75], v[4:5]
    v_pk_fma_f32 v[2:3], v[2:3], v[74:75], v[6:7]
    v_pk_fma_f32 v[6:7], v[24:25], v[4:5], v[2:3]
    v_pk_fma_f32 v[4:5], v[4:5], v[72:73], v[4:5]
    v_pk_fma_f32 v[2:3], v[2:3], v[72:73], v[6:7]
    v_pk_fma_f32 v[6:7], v[22:23], v[4:5], v[2:3]
    v_pk_fma_f32 v[4:5], v[4:5], v[10:11], v[4:5]
    v_pk_fma_f32 v[2:3], v[2:3], v[10:11], v[6:7]
    v_pk_fma_f32 v[6:7], v[20:21], v[4:5], v[2:3]
    v_pk_fma_f32 v[4:5], v[4:5], v[8:9], v[4:5]
    v_pk_fma_f32 v[2:3], v[2:3], v[8:9], v[6:7]
    v_pk_fma_f32 v[6:7], v[18:19], v[4:5], v[2:3]
    v_pk_fma_f32 v[4:5], v[4:5], v[106:107], v[4:5]
    v_pk_fma_f32 v[2:3], v[2:3], v[106:107], v[6:7]
    v_pk_fma_f32 v[6:7], v[16:17], v[4:5], v[2:3]
    v_pk_fma_f32 v[4:5], v[4:5], v[104:105], v[4:5]
    v_pk_fma_f32 v[2:3], v[2:3], v[104:105], v[6:7]
    v_rcp_f32 v122, v4
    v_rcp_f32 v123, v5
    s_getpc_b64 s[68:69]
    s_add_u32 s68, s68, s60
    v_pk_mul_f32 v[6:7], v[2:3], v[122:123]
    v_pk_fma_f32 v[122:123], v[4:5], s[70:71], v[6:7]
    v_pk_mov_b32 v[2:3], 0, 0
    v_pk_mov_b32 v[4:5], 1.0, 1.0
    v_pk_fma_f32 v[120:121], v[122:123], 0, v[120:121] op_sel_hi:[1,0,1]
    v_cvt_pk_bf16_f32 v6, v6, v7
    ds_write_addtid_b32 v6 offset:10240
    s_addc_u32 s69, s69, 0
    s_cmp_lg_u32 s47, 0
    s_nop 0
    s_setpc_b64 s[68:69]
    v_pk_fma_f32 v[6:7], v[18:19], v[4:5], v[2:3]
    v_pk_fma_f32 v[4:5], v[4:5], v[106:107], v[4:5]
    v_pk_fma_f32 v[2:3], v[2:3], v[106:107], v[6:7]
    v_pk_fma_f32 v[6:7], v[20:21], v[4:5], v[2:3]
    v_pk_fma_f32 v[4:5], v[4:5], v[8:9], v[4:5]
    v_pk_fma_f32 v[2:3], v[2:3], v[8:9], v[6:7]
    v_pk_fma_f32 v[6:7], v[22:23], v[4:5], v[2:3]
    v_pk_fma_f32 v[4:5], v[4:5], v[10:11], v[4:5]
    v_pk_fma_f32 v[2:3], v[2:3], v[10:11], v[6:7]
    v_pk_fma_f32 v[6:7], v[24:25], v[4:5], v[2:3]
    v_pk_fma_f32 v[4:5], v[4:5], v[72:73], v[4:5]
    v_pk_fma_f32 v[2:3], v[2:3], v[72:73], v[6:7]
    v_pk_fma_f32 v[6:7], v[26:27], v[4:5], v[2:3]
    v_pk_fma_f32 v[4:5], v[4:5], v[74:75], v[4:5]
    v_pk_fma_f32 v[2:3], v[2:3], v[74:75], v[6:7]
    v_pk_fma_f32 v[6:7], v[28:29], v[4:5], v[2:3]
    v_pk_fma_f32 v[4:5], v[4:5], v[76:77], v[4:5]
    v_pk_fma_f32 v[2:3], v[2:3], v[76:77], v[6:7]
    v_pk_fma_f32 v[6:7], v[30:31], v[4:5], v[2:3]
    v_pk_fma_f32 v[4:5], v[4:5], v[78:79], v[4:5]
    v_pk_fma_f32 v[2:3], v[2:3], v[78:79], v[6:7]
    s_cbranch_scc1 K3_LOOPEND
    s_sub_u32 s40, s40, 1
    s_cbranch_scc0 K3_BC0
    s_call_b64 s[66:67], K3_R
K3_BC0:
    ds_read2_b64 v[104:107], v13 offset0:0 offset1:1
    buffer_load_dword v72, v96, s[28:31], 0 offen
    buffer_load_dword v73, v97, s[28:31], 0 offen
    buffer_load_dword v74, v98, s[28:31], 0 offen
    buffer_load_dword v75, v99, s[28:31], 0 offen
    buffer_load_dword v76, v100, s[28:31], 0 offen
    buffer_load_dword v77, v101, s[28:31], 0 offen
    buffer_load_dword v78, v102, s[28:31], 0 offen
    buffer_load_dword v79, v103, s[28:31], 0 offen
    ds_read_b128 v[96:99], v12 offset:0
    ds_read_b128 v[100:103], v12 offset:16
    s_cbranch_scc1 K3_B1
    s_branch K3_F1
.p2align 3
K3_FR1:
    s_call_b64 s[66:67], K3_R
    s_branch K3_FC1
K3_B1:
    s_getpc_b64 s[68:69]
    s_add_u32 s68, s68, s57
    s_addc_u32 s69, s69, 0
    s_waitcnt vmcnt(24) lgkmcnt(0)
    v_pk_add_f32 v[6:7], v[48:49], v[122:123] neg_lo:[0,1] neg_hi:[0,1]
    s_cmp_lg_u32 s6, 0
    s_setpc_b64 s[68:69]
    v_pk_add_f32 v[34:35], v[34:35], v[6:7]
    v_pk_add_f32 v[36:37], v[36:37], v[6:7]
    v_pk_add_f32 v[38:39], v[38:39], v[6:7]
    v_pk_add_f32 v[40:41], v[40:41], v[6:7]
    v_pk_add_f32 v[42:43], v[42:43], v[6:7]
    v_pk_add_f32 v[44:45], v[44:45], v[6:7]
    v_pk_add_f32 v[46:47], v[46:47], v[6:7]
    v_mfma_f32_32x32x16_bf16 v[16:31], v[104:107], v[116:119], v[48:63]
    v_exp_f32 v104, v32
    v_exp_f32 v105, v33
    v_exp_f32 v106, v34
    v_exp_f32 v107, v35
    v_smfmac_f32_32x32x32_bf16 v[16:31], v[108:111], v[80:87], v112
    v_exp_f32 v8, v36
    v_exp_f32 v9, v37
    v_exp_f32 v10, v38
    v_exp_f32 v11, v39
    s_cbranch_scc1 K3_BS1
    v_exp_f32 v80, v40
    v_exp_f32 v81, v41
    v_exp_f32 v82, v42
    v_exp_f32 v83, v43
    v_exp_f32 v84, v44
    v_exp_f32 v85, v45
    v_exp_f32 v86, v46
    v_exp_f32 v87, v47
K3_BS1:
    s_mov_b64 s[28:29], s[100:101]
    s_getpc_b64 s[68:69]
    s_add_u32 s68, s68, s58
    s_addc_u32 s69, s69, 0
    s_setpc_b64 s[68:69]
    v_pk_fma_f32 v[6:7], v[46:47], v[4:5], v[2:3]
    v_pk_fma_f32 v[4:5], v[4:5], v[86:87], v[4:5]
    v_pk_fma_f32 v[2:3], v[2:3], v[86:87], v[6:7]
    v_pk_fma_f32 v[6:7], v[44:45], v[4:5], v[2:3]
    v_pk_fma_f32 v[4:5], v[4:5], v[84:85], v[4:5]
    v_pk_fma_f32 v[2:3], v[2:3], v[84:85], v[6:7]
    v_pk_fma_f32 v[6:7], v[42:43], v[4:5], v[2:3]
    v_pk_fma_f32 v[4:5], v[4:5], v[82:83], v[4:5]
    v_pk_fma_f32 v[2:3], v[2:3], v[82:83], v[6:7]
    v_pk_fma_f32 v[6:7], v[40:41], v[4:5], v[2:3]
    v_pk_fma_f32 v[4:5], v[4:5], v[80:81], v[4:5]
    v_pk_fma_f32 v[2:3], v[2:3], v[80:81], v[6:7]
    v_pk_fma_f32 v[6:7], v[38:39], v[4:5], v[2:3]
    v_pk_fma_f32 v[4:5], v[4:5], v[10:11], v[4:5]
    v_pk_fma_f32 v[2:3], v[2:3], v[10:11], v[6:7]
    v_pk_fma_f32 v[6:7], v[36:37], v[4:5], v[2:3]
    v_pk_fma_f32 v[4:5], v[4:5], v[8:9], v[4:5]
    v_pk_fma_f32 v[2:3], v[2:3], v[8:9], v[6:7]
    v_pk_fma_f32 v[6:7], v[34:35], v[4:5], v[2:3]
    v_pk_fma_f32 v[4:5], v[4:5], v[106:107], v[4:5]
    v_pk_fma_f32 v[2:3], v[2:3], v[106:107], v[6:7]
    v_pk_fma_f32 v[6:7], v[32:33], v[4:5], v[2:3]
    v_pk_fma_f32 v[4:5], v[4:5], v[104:105], v[4:5]
    v_pk_fma_f32 v[2:3], v[2:3], v[104:105], v[6:7]
    v_rcp_f32 v122, v4
    v_rcp_f32 v123, v5
    s_getpc_b64 s[68:69]
    s_add_u32 s68, s68, s60
    v_pk_mul_f32 v[6:7], v[2:3], v[122:123]
    v_pk_fma_f32 v[122:123], v[4:5], s[70:71], v[6:7]
    v_pk_mov_b32 v[2:3], 0, 0
    v_pk_mov_b32 v[4:5], 1.0, 1.0
    v_pk_fma_f32 v[120:121], v[122:123], 0, v[120:121] op_sel_hi:[1,0,1]
    v_cvt_pk_bf16_f32 v6, v6, v7
    ds_write_addtid_b32 v6 offset:10240
    s_addc_u32 s69, s69, 0
    s_cmp_lg_u32 s47, 0
    s_nop 0
    s_setpc_b64 s[68:69]
    v_pk_fma_f32 v[6:7], v[34:35], v[4:5], v[2:3]
    v_pk_fma_f32 v[4:5], v[4:5], v[106:107], v[4:5]
    v_pk_fma_f32 v[2:3], v[2:3], v[106:107], v[6:7]
    v_pk_fma_f32 v[6:7], v[36:37], v[4:5], v[2:3]
    v_pk_fma_f32 v[4:5], v[4:5], v[8:9], v[4:5]
    v_pk_fma_f32 v[2:3], v[2:3], v[8:9], v[6:7]
    v_pk_fma_f32 v[6:7], v[38:39], v[4:5], v[2:3]
    v_pk_fma_f32 v[4:5], v[4:5], v[10:11], v[4:5]
    v_pk_fma_f32 v[2:3], v[2:3], v[10:11], v[6:7]
    v_pk_fma_f32 v[6:7], v[40:41], v[4:5], v[2:3]
    v_pk_fma_f32 v[4:5], v[4:5], v[80:81], v[4:5]
    v_pk_fma_f32 v[2:3], v[2:3], v[80:81], v[6:7]
    v_pk_fma_f32 v[6:7], v[42:43], v[4:5], v[2:3]
    v_pk_fma_f32 v[4:5], v[4:5], v[82:83], v[4:5]
    v_pk_fma_f32 v[2:3], v[2:3], v[82:83], v[6:7]
    v_pk_fma_f32 v[6:7], v[44:45], v[4:5], v[2:3]
    v_pk_fma_f32 v[4:5], v[4:5], v[84:85], v[4:5]
    v_pk_fma_f32 v[2:3], v[2:3], v[84:85], v[6:7]
    v_pk_fma_f32 v[6:7], v[46:47], v[4:5], v[2:3]
    v_pk_fma_f32 v[4:5], v[4:5], v[86:87], v[4:5]
    v_pk_fma_f32 v[2:3], v[2:3], v[86:87], v[6:7]
    s_cbranch_scc1 K3_LOOPEND
    s_sub_u32 s40, s40, 1
    s_cbranch_scc0 K3_BC1
    s_call_b64 s[66:67], K3_R
K3_BC1:
    ds_read2_b64 v[104:107], v13 offset0:16 offset1:17
    buffer_load_dword v80, v96, s[28:31], 0 offen
    buffer_load_dword v81, v97, s[28:31], 0 offen
    buffer_load_dword v82, v98, s[28:31], 0 offen
    buffer_load_dword v83, v99, s[28:31], 0 offen
    buffer_load_dword v84, v100, s[28:31], 0 offen
    buffer_load_dword v85, v101, s[28:31], 0 offen
    buffer_load_dword v86, v102, s[28:31], 0 offen
    buffer_load_dword v87, v103, s[28:31], 0 offen
    ds_read_b128 v[96:99], v12 offset:32
    ds_read_b128 v[100:103], v12 offset:48
    s_cbranch_scc1 K3_B2
    s_branch K3_F2
.p2align 3
K3_FR2:
    s_call_b64 s[66:67], K3_R
    s_branch K3_FC2
K3_B2:
    s_getpc_b64 s[68:69]
    s_add_u32 s68, s68, s57
    s_addc_u32 s69, s69, 0
    s_waitcnt vmcnt(24) lgkmcnt(0)
    v_pk_add_f32 v[6:7], v[48:49], v[122:123] neg_lo:[0,1] neg_hi:[0,1]
    s_cmp_lg_u32 s6, 0
    s_setpc_b64 s[68:69]
    v_pk_add_f32 v[18:19], v[18:19], v[6:7]
    v_pk_add_f32 v[20:21], v[20:21], v[6:7]
    v_pk_add_f32 v[22:23], v[22:23], v[6:7]
    v_pk_add_f32 v[24:25], v[24:25], v[6:7]
    v_pk_add_f32 v[26:27], v[26:27], v[6:7]
    v_pk_add_f32 v[28:29], v[28:29], v[6:7]
    v_pk_add_f32 v[30:31], v[30:31], v[6:7]
    v_mfma_f32_32x32x16_bf16 v[32:47], v[104:107], v[116:119], v[48:63]
    v_exp_f32 v104, v16
    v_exp_f32 v105, v17
    v_exp_f32 v106, v18
    v_exp_f32 v107, v19
    v_smfmac_f32_32x32x32_bf16 v[32:47], v[108:111], v[88:95], v112
    v_exp_f32 v8, v20
    v_exp_f32 v9, v21
    v_exp_f32 v10, v22
    v_exp_f32 v11, v23
    s_cbranch_scc1 K3_BS2
    v_exp_f32 v88, v24
    v_exp_f32 v89, v25
    v_exp_f32 v90, v26
    v_exp_f32 v91, v27
    v_exp_f32 v92, v28
    v_exp_f32 v93, v29
    v_exp_f32 v94, v30
    v_exp_f32 v95, v31
K3_BS2:
    s_mov_b64 s[28:29], s[100:101]
    s_getpc_b64 s[68:69]
    s_add_u32 s68, s68, s58
    s_addc_u32 s69, s69, 0
    s_setpc_b64 s[68:69]
    v_pk_fma_f32 v[6:7], v[30:31], v[4:5], v[2:3]
    v_pk_fma_f32 v[4:5], v[4:5], v[94:95], v[4:5]
    v_pk_fma_f32 v[2:3], v[2:3], v[94:95], v[6:7]
    v_pk_fma_f32 v[6:7], v[28:29], v[4:5], v[2:3]
    v_pk_fma_f32 v[4:5], v[4:5], v[92:93], v[4:5]
    v_pk_fma_f32 v[2:3], v[2:3], v[92:93], v[6:7]
    v_pk_fma_f32 v[6:7], v[26:27], v[4:5], v[2:3]
    v_pk_fma_f32 v[4:5], v[4:5], v[90:91], v[4:5]
    v_pk_fma_f32 v[2:3], v[2:3], v[90:91], v[6:7]
    v_pk_fma_f32 v[6:7], v[24:25], v[4:5], v[2:3]
    v_pk_fma_f32 v[4:5], v[4:5], v[88:89], v[4:5]
    v_pk_fma_f32 v[2:3], v[2:3], v[88:89], v[6:7]
    v_pk_fma_f32 v[6:7], v[22:23], v[4:5], v[2:3]
    v_pk_fma_f32 v[4:5], v[4:5], v[10:11], v[4:5]
    v_pk_fma_f32 v[2:3], v[2:3], v[10:11], v[6:7]
    v_pk_fma_f32 v[6:7], v[20:21], v[4:5], v[2:3]
    v_pk_fma_f32 v[4:5], v[4:5], v[8:9], v[4:5]
    v_pk_fma_f32 v[2:3], v[2:3], v[8:9], v[6:7]
    v_pk_fma_f32 v[6:7], v[18:19], v[4:5], v[2:3]
    v_pk_fma_f32 v[4:5], v[4:5], v[106:107], v[4:5]
    v_pk_fma_f32 v[2:3], v[2:3], v[106:107], v[6:7]
    v_pk_fma_f32 v[6:7], v[16:17], v[4:5], v[2:3]
    v_pk_fma_f32 v[4:5], v[4:5], v[104:105], v[4:5]
    v_pk_fma_f32 v[2:3], v[2:3], v[104:105], v[6:7]
    v_rcp_f32 v122, v4
    v_rcp_f32 v123, v5
    s_getpc_b64 s[68:69]
    s_add_u32 s68, s68, s60
    v_pk_mul_f32 v[6:7], v[2:3], v[122:123]
    v_pk_fma_f32 v[122:123], v[4:5], s[70:71], v[6:7]
    v_pk_mov_b32 v[2:3], 0, 0
    v_pk_mov_b32 v[4:5], 1.0, 1.0
    v_pk_fma_f32 v[120:121], v[122:123], 0, v[120:121] op_sel_hi:[1,0,1]
    v_cvt_pk_bf16_f32 v6, v6, v7
    ds_write_addtid_b32 v6 offset:10240
    s_addc_u32 s69, s69, 0
    s_cmp_lg_u32 s47, 0
    s_nop 0
    s_setpc_b64 s[68:69]
    v_pk_fma_f32 v[6:7], v[18:19], v[4:5], v[2:3]
    v_pk_fma_f32 v[4:5], v[4:5], v[106:107], v[4:5]
    v_pk_fma_f32 v[2:3], v[2:3], v[106:107], v[6:7]
    v_pk_fma_f32 v[6:7], v[20:21], v[4:5], v[2:3]
    v_pk_fma_f32 v[4:5], v[4:5], v[8:9], v[4:5]
    v_pk_fma_f32 v[2:3], v[2:3], v[8:9], v[6:7]
    v_pk_fma_f32 v[6:7], v[22:23], v[4:5], v[2:3]
    v_pk_fma_f32 v[4:5], v[4:5], v[10:11], v[4:5]
    v_pk_fma_f32 v[2:3], v[2:3], v[10:11], v[6:7]
    v_pk_fma_f32 v[6:7], v[24:25], v[4:5], v[2:3]
    v_pk_fma_f32 v[4:5], v[4:5], v[88:89], v[4:5]
    v_pk_fma_f32 v[2:3], v[2:3], v[88:89], v[6:7]
    v_pk_fma_f32 v[6:7], v[26:27], v[4:5], v[2:3]
    v_pk_fma_f32 v[4:5], v[4:5], v[90:91], v[4:5]
    v_pk_fma_f32 v[2:3], v[2:3], v[90:91], v[6:7]
    v_pk_fma_f32 v[6:7], v[28:29], v[4:5], v[2:3]
    v_pk_fma_f32 v[4:5], v[4:5], v[92:93], v[4:5]
    v_pk_fma_f32 v[2:3], v[2:3], v[92:93], v[6:7]
    v_pk_fma_f32 v[6:7], v[30:31], v[4:5], v[2:3]
    v_pk_fma_f32 v[4:5], v[4:5], v[94:95], v[4:5]
    v_pk_fma_f32 v[2:3], v[2:3], v[94:95], v[6:7]
    s_cbranch_scc1 K3_LOOPEND
    s_sub_u32 s40, s40, 1
    s_cbranch_scc0 K3_BC2
    s_call_b64 s[66:67], K3_R
K3_BC2:
    ds_read2_b64 v[104:107], v13 offset0:32 offset1:33
    buffer_load_dword v88, v96, s[28:31], 0 offen
    buffer_load_dword v89, v97, s[28:31], 0 offen
    buffer_load_dword v90, v98, s[28:31], 0 offen
    buffer_load_dword v91, v99, s[28:31], 0 offen
    buffer_load_dword v92, v100, s[28:31], 0 offen
    buffer_load_dword v93, v101, s[28:31], 0 offen
    buffer_load_dword v94, v102, s[28:31], 0 offen
    buffer_load_dword v95, v103, s[28:31], 0 offen
    ds_read_b128 v[96:99], v12 offset:64
    ds_read_b128 v[100:103], v12 offset:80
    s_cbranch_scc1 K3_B3
    s_branch K3_F3
.p2align 3
K3_FR3:
    s_call_b64 s[66:67], K3_R
    s_branch K3_FC3
K3_B3:
    s_getpc_b64 s[68:69]
    s_add_u32 s68, s68, s57
    s_addc_u32 s69, s69, 0
    s_waitcnt vmcnt(24) lgkmcnt(0)
    v_pk_add_f32 v[6:7], v[48:49], v[122:123] neg_lo:[0,1] neg_hi:[0,1]
    s_cmp_lg_u32 s6, 0
    s_setpc_b64 s[68:69]
    v_pk_add_f32 v[34:35], v[34:35], v[6:7]
    v_pk_add_f32 v[36:37], v[36:37], v[6:7]
    v_pk_add_f32 v[38:39], v[38:39], v[6:7]
    v_pk_add_f32 v[40:41], v[40:41], v[6:7]
    v_pk_add_f32 v[42:43], v[42:43], v[6:7]
    v_pk_add_f32 v[44:45], v[44:45], v[6:7]
    v_pk_add_f32 v[46:47], v[46:47], v[6:7]
    v_mfma_f32_32x32x16_bf16 v[16:31], v[104:107], v[116:119], v[48:63]
    v_exp_f32 v104, v32
    v_exp_f32 v105, v33
    v_exp_f32 v106, v34
    v_exp_f32 v107, v35
    v_smfmac_f32_32x32x32_bf16 v[16:31], v[108:111], v[64:71], v112
    v_exp_f32 v8, v36
    v_exp_f32 v9, v37
    v_exp_f32 v10, v38
    v_exp_f32 v11, v39
    s_cbranch_scc1 K3_BS3
    v_exp_f32 v64, v40
    v_exp_f32 v65, v41
    v_exp_f32 v66, v42
    v_exp_f32 v67, v43
    v_exp_f32 v68, v44
    v_exp_f32 v69, v45
    v_exp_f32 v70, v46
    v_exp_f32 v71, v47
K3_BS3:
    s_mov_b64 s[28:29], s[100:101]
    s_getpc_b64 s[68:69]
    s_add_u32 s68, s68, s58
    s_addc_u32 s69, s69, 0
    s_setpc_b64 s[68:69]
    v_pk_fma_f32 v[6:7], v[46:47], v[4:5], v[2:3]
    v_pk_fma_f32 v[4:5], v[4:5], v[70:71], v[4:5]
    v_pk_fma_f32 v[2:3], v[2:3], v[70:71], v[6:7]
    v_pk_fma_f32 v[6:7], v[44:45], v[4:5], v[2:3]
    v_pk_fma_f32 v[4:5], v[4:5], v[68:69], v[4:5]
    v_pk_fma_f32 v[2:3], v[2:3], v[68:69], v[6:7]
    v_pk_fma_f32 v[6:7], v[42:43], v[4:5], v[2:3]
    v_pk_fma_f32 v[4:5], v[4:5], v[66:67], v[4:5]
    v_pk_fma_f32 v[2:3], v[2:3], v[66:67], v[6:7]
    v_pk_fma_f32 v[6:7], v[40:41], v[4:5], v[2:3]
    v_pk_fma_f32 v[4:5], v[4:5], v[64:65], v[4:5]
    v_pk_fma_f32 v[2:3], v[2:3], v[64:65], v[6:7]
    v_pk_fma_f32 v[6:7], v[38:39], v[4:5], v[2:3]
    v_pk_fma_f32 v[4:5], v[4:5], v[10:11], v[4:5]
    v_pk_fma_f32 v[2:3], v[2:3], v[10:11], v[6:7]
    v_pk_fma_f32 v[6:7], v[36:37], v[4:5], v[2:3]
    v_pk_fma_f32 v[4:5], v[4:5], v[8:9], v[4:5]
    v_pk_fma_f32 v[2:3], v[2:3], v[8:9], v[6:7]
    v_pk_fma_f32 v[6:7], v[34:35], v[4:5], v[2:3]
    v_pk_fma_f32 v[4:5], v[4:5], v[106:107], v[4:5]
    v_pk_fma_f32 v[2:3], v[2:3], v[106:107], v[6:7]
    v_pk_fma_f32 v[6:7], v[32:33], v[4:5], v[2:3]
    v_pk_fma_f32 v[4:5], v[4:5], v[104:105], v[4:5]
    v_pk_fma_f32 v[2:3], v[2:3], v[104:105], v[6:7]
    v_rcp_f32 v122, v4
    v_rcp_f32 v123, v5
    s_getpc_b64 s[68:69]
    s_add_u32 s68, s68, s60
    v_pk_mul_f32 v[6:7], v[2:3], v[122:123]
    v_pk_fma_f32 v[122:123], v[4:5], s[70:71], v[6:7]
    v_pk_mov_b32 v[2:3], 0, 0
    v_pk_mov_b32 v[4:5], 1.0, 1.0
    v_pk_fma_f32 v[120:121], v[122:123], 0, v[120:121] op_sel_hi:[1,0,1]
    v_cvt_pk_bf16_f32 v6, v6, v7
    ds_write_addtid_b32 v6 offset:10240
    s_addc_u32 s69, s69, 0
    s_cmp_lg_u32 s47, 0
    s_nop 0
    s_setpc_b64 s[68:69]
    v_pk_fma_f32 v[6:7], v[34:35], v[4:5], v[2:3]
    v_pk_fma_f32 v[4:5], v[4:5], v[106:107], v[4:5]
    v_pk_fma_f32 v[2:3], v[2:3], v[106:107], v[6:7]
    v_pk_fma_f32 v[6:7], v[36:37], v[4:5], v[2:3]
    v_pk_fma_f32 v[4:5], v[4:5], v[8:9], v[4:5]
    v_pk_fma_f32 v[2:3], v[2:3], v[8:9], v[6:7]
    v_pk_fma_f32 v[6:7], v[38:39], v[4:5], v[2:3]
    v_pk_fma_f32 v[4:5], v[4:5], v[10:11], v[4:5]
    v_pk_fma_f32 v[2:3], v[2:3], v[10:11], v[6:7]
    v_pk_fma_f32 v[6:7], v[40:41], v[4:5], v[2:3]
    v_pk_fma_f32 v[4:5], v[4:5], v[64:65], v[4:5]
    v_pk_fma_f32 v[2:3], v[2:3], v[64:65], v[6:7]
    v_pk_fma_f32 v[6:7], v[42:43], v[4:5], v[2:3]
    v_pk_fma_f32 v[4:5], v[4:5], v[66:67], v[4:5]
    v_pk_fma_f32 v[2:3], v[2:3], v[66:67], v[6:7]
    v_pk_fma_f32 v[6:7], v[44:45], v[4:5], v[2:3]
    v_pk_fma_f32 v[4:5], v[4:5], v[68:69], v[4:5]
    v_pk_fma_f32 v[2:3], v[2:3], v[68:69], v[6:7]
    v_pk_fma_f32 v[6:7], v[46:47], v[4:5], v[2:3]
    v_pk_fma_f32 v[4:5], v[4:5], v[70:71], v[4:5]
    v_pk_fma_f32 v[2:3], v[2:3], v[70:71], v[6:7]
    s_cbranch_scc1 K3_LOOPEND
    s_sub_u32 s40, s40, 1
    s_cbranch_scc0 K3_BC3
    s_call_b64 s[66:67], K3_R
K3_BC3:
    ds_read2_b64 v[104:107], v13 offset0:48 offset1:49
    buffer_load_dword v64, v96, s[28:31], 0 offen
    buffer_load_dword v65, v97, s[28:31], 0 offen
    buffer_load_dword v66, v98, s[28:31], 0 offen
    buffer_load_dword v67, v99, s[28:31], 0 offen
    buffer_load_dword v68, v100, s[28:31], 0 offen
    buffer_load_dword v69, v101, s[28:31], 0 offen
    buffer_load_dword v70, v102, s[28:31], 0 offen
    buffer_load_dword v71, v103, s[28:31], 0 offen
    ds_read_b128 v[96:99], v12 offset:96
    ds_read_b128 v[100:103], v12 offset:112
    v_add_u32 v12, 128, v12
    v_lshl_add_u32 v13, v14, 2, v13
    s_cbranch_scc1 K3_B0
    s_branch K3_F0
K3_R:
    s_cmp_eq_u32 s42, s45
    s_cbranch_scc1 K3_RSTOP
K3_RNR:
    s_cmp_eq_u32 s42, s41
    s_cbranch_scc1 K3_RLAST
    s_cmp_le_u32 s61, 8
    s_cbranch_scc1 K3_RNN
    v_rcp_f32 v6, v4
    v_rcp_f32 v7, v5
    v_pk_mul_f32 v[4:5], v[4:5], s[70:71]
    v_pk_mul_f32 v[2:3], v[2:3], v[6:7]
    v_pk_fma_f32 v[120:121], v[4:5], 0, v[120:121] op_sel_hi:[1,0,1]
    v_pk_mov_b32 v[4:5], 1.0, 1.0
K3_RNN:
    s_max_i32 s62, s41, s45
    s_sub_u32 s63, s42, 8
    s_max_i32 s62, s62, s63
    s_sub_u32 s40, s42, s62
    s_sub_u32 s40, s40, 1
    s_mov_b32 s42, s62
    s_cmp_lg_u32 0, 0
    s_setpc_b64 s[66:67]
K3_RLAST:
    s_sub_u32 s62, s46, 71952
    s_lshr_b32 s62, s62, 1
    s_add_u32 m0, s62, s44
    v_pk_mov_b32 v[122:123], v[48:49], v[48:49] op_sel:[0,1]
    s_mul_i32 s60, s43, 24
    s_sub_u32 s58, 180, s60
    s_cmp_eq_u64 s[48:49], 0
    s_cbranch_scc1 K3_RPE
    s_lshl_b32 s57, s43, 3
    s_add_u32 s57, s57, 28
    s_add_u32 s60, s60, 76
    s_mov_b32 s6, 0
K3_RNS:
    s_ff1_i32_b64 s62, s[48:49]
    s_bitset0_b64 s[48:49], s62
    v_readlane_b32 s63, v1, s62
    s_mul_i32 s44, s62, 528
    s_mul_i32 s62, s62, 1024
    s_add_u32 s62, s62, s46
    v_lshl_add_u32 v124, v0, 1, s62
    ds_read2_b64 v[48:51], v124 offset0:0 offset1:0
    ds_read2_b64 v[52:55], v124 offset0:0 offset1:0
    ds_read2_b64 v[56:59], v124 offset0:0 offset1:0
    ds_read2_b64 v[60:63], v124 offset0:0 offset1:0
    s_and_b32 s43, s63, 7
    s_lshr_b32 s41, s63, 3
    s_sub_u32 s41, s52, s41
    s_sub_u32 s61, s42, s41
    s_max_i32 s62, s41, s45
    s_sub_u32 s63, s42, 8
    s_max_i32 s62, s62, s63
    s_sub_u32 s40, s42, s62
    s_sub_u32 s40, s40, 1
    s_mov_b32 s42, s62
    s_cmp_eq_u32 0, 0
    s_setpc_b64 s[66:67]
K3_RPE:
    s_mov_b32 s57, 84
    s_mov_b32 s60, 244
    s_cmp_lt_u32 s43, 4
    s_cselect_b32 s6, 1, 0
    s_cmp_eq_u32 s46, 71952
    s_cbranch_scc1 K3_RSW
    s_mov_b32 s47, 1
    s_cmp_eq_u32 0, 0
    s_setpc_b64 s[66:67]
K3_RSW:
    s_cmp_lg_u32 s55, 0
    s_cbranch_scc1 K3_QW0X
    v_mov_b32 v124, 0
K3_QW0:
    ds_read_b32 v116, v124 offset:292
    s_waitcnt lgkmcnt(0)
    v_readfirstlane_b32 s62, v116
    s_cmp_lt_u32 s62, 4
    s_cbranch_scc1 K3_QW0
K3_QW0X:
    s_mov_b32 s46, 72464
    s_mov_b32 s42, s5
    s_add_u32 s52, s4, s5
    s_sub_u32 s52, s52, 1
    s_mov_b64 s[48:49], s[50:51]
    v_lshlrev_b32 v124, 2, v0
    ds_read_b128 v[116:119], v124 offset:37136
    v_mad_i32_i24 v13, v14, s7, v13
    s_setprio 3
    s_cmp_gt_u32 s42, 11
    s_cselect_b32 s45, 11, 4
    s_branch K3_RNS
K3_RSTOP:
    s_cmp_lg_u32 s45, 4
    s_cbranch_scc1 K3_RSP
    v_add_u32 v12, s54, v12
    s_mov_b64 s[100:101], s[98:99]
    s_add_u32 s62, s4, s5
    s_sub_u32 s62, 260, s62
    s_lshl_b32 s54, s62, 5
    s_cmp_eq_u32 s46, 71952
    s_cselect_b32 s45, -1, 3
    s_branch K3_RNR
K3_RSP:
    s_cmp_lt_u32 s45, 4
    s_cbranch_scc1 K3_RSP0
    s_setprio 2
    s_mov_b32 s45, 4
    s_branch K3_RNR
K3_RSP0:
    s_mov_b32 s30, 0
    s_cmp_lg_u32 s45, 3
    s_cbranch_scc1 K3_RSP1
    s_setprio 1
    s_mov_b32 s45, 0
    s_branch K3_RNR
K3_RSP1:
    s_setprio 0
    s_mov_b32 s45, -1
    s_branch K3_RNR
K3_SIMPLE:
    s_waitcnt vmcnt(0) lgkmcnt(0)
    v_lshrrev_b32 v14, 3, v14
    v_mov_b32 v96, v10
    s_lshl_b32 s62, s53, 3
    s_sub_u32 s62, 0, s62
    v_mad_i32_i24 v97, v14, s62, v13
K3_SPH:
    s_cmp_eq_u64 s[48:49], 0
    s_cbranch_scc1 K3_SNEXT
    s_ff1_i32_b64 s64, s[48:49]
    v_readlane_b32 s42, v96, s64
    v_readlane_b32 s57, v1, s64
    s_ff1_i32_b64 s62, s[48:49]
    s_bitset0_b64 s[48:49], s62
    v_readlane_b32 s63, v1, s62
    s_mul_i32 s44, s62, 528
    s_mul_i32 s62, s62, 1024
    s_add_u32 s62, s62, s46
    v_lshl_add_u32 v124, v0, 1, s62
    ds_read2_b64 v[48:51], v124 offset0:0 offset1:0
    ds_read2_b64 v[52:55], v124 offset0:0 offset1:0
    ds_read2_b64 v[56:59], v124 offset0:0 offset1:0
    ds_read2_b64 v[60:63], v124 offset0:0 offset1:0
    s_and_b32 s43, s63, 7
    s_lshr_b32 s41, s63, 3
    s_sub_u32 s41, s52, s41
    s_sub_u32 s61, s42, s41
    s_sub_u32 s57, s57, s42
    s_add_u32 s57, s57, 1
    s_sub_u32 s62, s46, 71952
    s_lshr_b32 s62, s62, 1
    s_add_u32 m0, s62, s44
K3_STILE:
    s_lshl_b32 s62, s57, 2
    s_add_u32 s62, s62, 1024
    v_mov_b32 v12, s62
    v_mad_u32_u24 v13, v14, s57, v97
    ds_read2_b32 v[64:65], v12 offset0:0 offset1:1
    ds_read2_b32 v[66:67], v12 offset0:2 offset1:3
    ds_read2_b32 v[68:69], v12 offset0:4 offset1:5
    ds_read2_b32 v[70:71], v12 offset0:6 offset1:7
    ds_read2_b64 v[104:107], v13 offset0:0 offset1:1
    s_min_u32 s56, s42, 8
    s_sub_u32 s42, s42, s56
    s_add_u32 s57, s57, 8
    s_waitcnt lgkmcnt(0)
    buffer_load_dword v64, v64, s[28:31], 0 offen
    buffer_load_dword v65, v65, s[28:31], 0 offen
    buffer_load_dword v66, v66, s[28:31], 0 offen
    buffer_load_dword v67, v67, s[28:31], 0 offen
    buffer_load_dword v68, v68, s[28:31], 0 offen
    buffer_load_dword v69, v69, s[28:31], 0 offen
    buffer_load_dword v70, v70, s[28:31], 0 offen
    buffer_load_dword v71, v71, s[28:31], 0 offen
    s_waitcnt vmcnt(0)
    v_mfma_f32_32x32x16_bf16 v[16:31], v[104:107], v[116:119], v[48:63]
    v_smfmac_f32_32x32x32_bf16 v[16:31], v[108:111], v[64:71], v112
    s_nop 11
    v_exp_f32 v8, v16
    v_exp_f32 v9, v17
    s_cmp_eq_u32 s56, 1
    v_pk_add_f32 v[8:9], v[8:9], 1.0 op_sel_hi:[1,0]
    v_rcp_f32 v8, v8
    v_rcp_f32 v9, v9
    s_nop 0
    v_pk_fma_f32 v[2:3], v[16:17], v[8:9], v[2:3]
    s_cbranch_scc1 K3_SFL
    v_exp_f32 v8, v18
    v_exp_f32 v9, v19
    s_cmp_eq_u32 s56, 2
    v_pk_add_f32 v[8:9], v[8:9], 1.0 op_sel_hi:[1,0]
    v_rcp_f32 v8, v8
    v_rcp_f32 v9, v9
    s_nop 0
    v_pk_fma_f32 v[2:3], v[18:19], v[8:9], v[2:3]
    s_cbranch_scc1 K3_SFL
    v_exp_f32 v8, v20
    v_exp_f32 v9, v21
    s_cmp_eq_u32 s56, 3
    v_pk_add_f32 v[8:9], v[8:9], 1.0 op_sel_hi:[1,0]
    v_rcp_f32 v8, v8
    v_rcp_f32 v9, v9
    s_nop 0
    v_pk_fma_f32 v[2:3], v[20:21], v[8:9], v[2:3]
    s_cbranch_scc1 K3_SFL
    v_exp_f32 v8, v22
    v_exp_f32 v9, v23
    s_cmp_eq_u32 s56, 4
    v_pk_add_f32 v[8:9], v[8:9], 1.0 op_sel_hi:[1,0]
    v_rcp_f32 v8, v8
    v_rcp_f32 v9, v9
    s_nop 0
    v_pk_fma_f32 v[2:3], v[22:23], v[8:9], v[2:3]
    s_cbranch_scc1 K3_SFL
    v_exp_f32 v8, v24
    v_exp_f32 v9, v25
    s_cmp_eq_u32 s56, 5
    v_pk_add_f32 v[8:9], v[8:9], 1.0 op_sel_hi:[1,0]
    v_rcp_f32 v8, v8
    v_rcp_f32 v9, v9
    s_nop 0
    v_pk_fma_f32 v[2:3], v[24:25], v[8:9], v[2:3]
    s_cbranch_scc1 K3_SFL
    v_exp_f32 v8, v26
    v_exp_f32 v9, v27
    s_cmp_eq_u32 s56, 6
    v_pk_add_f32 v[8:9], v[8:9], 1.0 op_sel_hi:[1,0]
    v_rcp_f32 v8, v8
    v_rcp_f32 v9, v9
    s_nop 0
    v_pk_fma_f32 v[2:3], v[26:27], v[8:9], v[2:3]
    s_cbranch_scc1 K3_SFL
    v_exp_f32 v8, v28
    v_exp_f32 v9, v29
    s_cmp_eq_u32 s56, 7
    v_pk_add_f32 v[8:9], v[8:9], 1.0 op_sel_hi:[1,0]
    v_rcp_f32 v8, v8
    v_rcp_f32 v9, v9
    s_nop 0
    v_pk_fma_f32 v[2:3], v[28:29], v[8:9], v[2:3]
    s_cbranch_scc1 K3_SFL
    v_exp_f32 v8, v30
    v_exp_f32 v9, v31
    s_cmp_eq_u32 s56, 8
    v_pk_add_f32 v[8:9], v[8:9], 1.0 op_sel_hi:[1,0]
    v_rcp_f32 v8, v8
    v_rcp_f32 v9, v9
    s_nop 0
    v_pk_fma_f32 v[2:3], v[30:31], v[8:9], v[2:3]
    s_cmp_lg_u32 s42, 0
    s_cbranch_scc1 K3_STILE
K3_SFL:
    v_rcp_f32 v122, v4
    v_rcp_f32 v123, v5
    s_getpc_b64 s[68:69]
    s_add_u32 s68, s68, s60
    v_pk_mul_f32 v[6:7], v[2:3], v[122:123]
    v_pk_fma_f32 v[122:123], v[4:5], s[70:71], v[6:7]
    v_pk_mov_b32 v[2:3], 0, 0
    v_pk_mov_b32 v[4:5], 1.0, 1.0
    v_pk_fma_f32 v[120:121], v[122:123], 0, v[120:121] op_sel_hi:[1,0,1]
    v_cvt_pk_bf16_f32 v6, v6, v7
    ds_write_addtid_b32 v6 offset:10240
    s_branch K3_SPH
K3_SNEXT:
    s_cmp_lg_u32 s46, 71952
    s_cbranch_scc1 K3_SEND
    s_cmp_lg_u32 s55, 0
    s_cbranch_scc1 K3_QW1X
    v_mov_b32 v124, 0
K3_QW1:
    ds_read_b32 v116, v124 offset:292
    s_waitcnt lgkmcnt(0)
    v_readfirstlane_b32 s62, v116
    s_cmp_lt_u32 s62, 4
    s_cbranch_scc1 K3_QW1
K3_QW1X:
    s_mov_b32 s46, 72464
    s_mov_b64 s[28:29], s[98:99]
    s_mov_b64 s[48:49], s[50:51]
    v_lshlrev_b32 v124, 2, v0
    ds_read_b128 v[116:119], v124 offset:37136
    s_branch K3_SPH
K3_SEND:
    v_pk_mov_b32 v[120:121], 0, 0
    s_branch K3_LOOPEND
K3_QSUB:
    ds_read_b128 v[48:51], v122 offset:0
    ds_read_b128 v[52:55], v122 offset:8704
    ds_read_b128 v[56:59], v122 offset:32
    ds_read_b128 v[60:63], v122 offset:8736
    s_waitcnt lgkmcnt(3)
    v_mfma_f32_32x32x16_bf16 v[16:31], v[48:51], v[64:67], 0
    ds_read_b128 v[48:51], v122 offset:64
    s_waitcnt lgkmcnt(3)
    v_mfma_f32_32x32x16_bf16 v[32:47], v[52:55], v[64:67], 0
    ds_read_b128 v[52:55], v122 offset:8768
    s_waitcnt lgkmcnt(3)
    v_mfma_f32_32x32x16_bf16 v[16:31], v[56:59], v[68:71], v[16:31]
    ds_read_b128 v[56:59], v122 offset:96
    s_waitcnt lgkmcnt(3)
    v_mfma_f32_32x32x16_bf16 v[32:47], v[60:63], v[68:71], v[32:47]
    ds_read_b128 v[60:63], v122 offset:8800
    s_waitcnt lgkmcnt(3)
    v_mfma_f32_32x32x16_bf16 v[16:31], v[48:51], v[72:75], v[16:31]
    ds_read_b128 v[48:51], v122 offset:128
    s_waitcnt lgkmcnt(3)
    v_mfma_f32_32x32x16_bf16 v[32:47], v[52:55], v[72:75], v[32:47]
    ds_read_b128 v[52:55], v122 offset:8832
    s_waitcnt lgkmcnt(3)
    v_mfma_f32_32x32x16_bf16 v[16:31], v[56:59], v[76:79], v[16:31]
    ds_read_b128 v[56:59], v122 offset:160
    s_waitcnt lgkmcnt(3)
    v_mfma_f32_32x32x16_bf16 v[32:47], v[60:63], v[76:79], v[32:47]
    ds_read_b128 v[60:63], v122 offset:8864
    s_waitcnt lgkmcnt(3)
    v_mfma_f32_32x32x16_bf16 v[16:31], v[48:51], v[80:83], v[16:31]
    ds_read_b128 v[48:51], v122 offset:192
    s_waitcnt lgkmcnt(3)
    v_mfma_f32_32x32x16_bf16 v[32:47], v[52:55], v[80:83], v[32:47]
    ds_read_b128 v[52:55], v122 offset:8896
    s_waitcnt lgkmcnt(3)
    v_mfma_f32_32x32x16_bf16 v[16:31], v[56:59], v[84:87], v[16:31]
    ds_read_b128 v[56:59], v122 offset:224
    s_waitcnt lgkmcnt(3)
    v_mfma_f32_32x32x16_bf16 v[32:47], v[60:63], v[84:87], v[32:47]
    ds_read_b128 v[60:63], v122 offset:8928
    s_waitcnt lgkmcnt(3)
    v_mfma_f32_32x32x16_bf16 v[16:31], v[48:51], v[88:91], v[16:31]
    s_waitcnt lgkmcnt(2)
    v_mfma_f32_32x32x16_bf16 v[32:47], v[52:55], v[88:91], v[32:47]
    s_waitcnt lgkmcnt(1)
    v_mfma_f32_32x32x16_bf16 v[16:31], v[56:59], v[92:95], v[16:31]
    s_waitcnt lgkmcnt(0)
    v_mfma_f32_32x32x16_bf16 v[32:47], v[60:63], v[92:95], v[32:47]
    v_mov_b32 v8, v1
    v_mov_b32 v9, v1
    s_cmp_lg_u32 s19, 0
    s_cbranch_scc1 K3_QS2
    s_lshl_b32 s14, s3, 13
    s_add_u32 s14, s14, 11301376
    v_lshl_add_u32 v2, v0, 2, s14
    v_add_u32 v3, 0x1000, v2
    buffer_load_dwordx4 v[64:67], v2, s[20:23], 0 offen offset:0
    buffer_load_dwordx4 v[68:71], v2, s[20:23], 0 offen offset:1024
    buffer_load_dwordx4 v[72:75], v2, s[20:23], 0 offen offset:2048
    buffer_load_dwordx4 v[76:79], v2, s[20:23], 0 offen offset:3072
    buffer_load_dwordx4 v[80:83], v3, s[20:23], 0 offen offset:0
    buffer_load_dwordx4 v[84:87], v3, s[20:23], 0 offen offset:1024
    buffer_load_dwordx4 v[88:91], v3, s[20:23], 0 offen offset:2048
    buffer_load_dwordx4 v[92:95], v3, s[20:23], 0 offen offset:3072
    s_lshl_b32 s14, s3, 7
    s_add_u32 s15, s14, 11499008
    v_and_b32 v2, 124, v0
    v_add_u32 v3, s15, v2
    buffer_load_dword v1, v3, s[20:23], 0 offen
K3_QS2:
    s_mov_b32 s14, 0xbfb8aa3b
    s_mov_b32 s15, 0xbfb8aa3b
    s_nop 5
    v_pk_fma_f32 v[16:17], v[16:17], s[14:15], v[8:9]
    ds_write2st64_b32 v123, v16, v17 offset0:0 offset1:4
    v_pk_fma_f32 v[18:19], v[18:19], s[14:15], v[8:9]
    ds_write2st64_b32 v123, v18, v19 offset0:8 offset1:12
    v_pk_fma_f32 v[20:21], v[20:21], s[14:15], v[8:9]
    ds_write2st64_b32 v123, v20, v21 offset0:32 offset1:36
    v_pk_fma_f32 v[22:23], v[22:23], s[14:15], v[8:9]
    ds_write2st64_b32 v123, v22, v23 offset0:40 offset1:44
    v_pk_fma_f32 v[24:25], v[24:25], s[14:15], v[8:9]
    ds_write2st64_b32 v123, v24, v25 offset0:64 offset1:68
    v_pk_fma_f32 v[26:27], v[26:27], s[14:15], v[8:9]
    ds_write2st64_b32 v123, v26, v27 offset0:72 offset1:76
    v_pk_fma_f32 v[28:29], v[28:29], s[14:15], v[8:9]
    ds_write2st64_b32 v123, v28, v29 offset0:96 offset1:100
    v_pk_fma_f32 v[30:31], v[30:31], s[14:15], v[8:9]
    ds_write2st64_b32 v123, v30, v31 offset0:104 offset1:108
    v_pk_fma_f32 v[32:33], v[32:33], s[14:15], v[8:9]
    ds_write2st64_b32 v123, v32, v33 offset0:128 offset1:132
    v_pk_fma_f32 v[34:35], v[34:35], s[14:15], v[8:9]
    ds_write2st64_b32 v123, v34, v35 offset0:136 offset1:140
    v_pk_fma_f32 v[36:37], v[36:37], s[14:15], v[8:9]
    ds_write2st64_b32 v123, v36, v37 offset0:160 offset1:164
    v_pk_fma_f32 v[38:39], v[38:39], s[14:15], v[8:9]
    ds_write2st64_b32 v123, v38, v39 offset0:168 offset1:172
    s_mov_b32 exec_hi, 0
    v_fma_f32 v40, v40, s14, v9
    ds_write_b32 v123, v40 offset:49152
    s_mov_b64 exec, -1
    s_setpc_b64 s[66:67]
K3_CLAMP:
    v_sub_u32 v2, 1880, v5
    v_max_i32 v2, 0, v2
    v_min_u32 v10, v10, v2
    s_mov_b32 s18, 1
    v_mov_b32 v6, v10
    s_nop 1
    v_add_u32_dpp v6, v6, v6 row_shr:1 row_mask:0xf bank_mask:0xf bound_ctrl:0
    s_nop 1
    v_add_u32_dpp v6, v6, v6 row_shr:2 row_mask:0xf bank_mask:0xf bound_ctrl:0
    s_nop 1
    v_add_u32_dpp v6, v6, v6 row_shr:4 row_mask:0xf bank_mask:0xf bound_ctrl:0
    s_nop 1
    v_add_u32_dpp v6, v6, v6 row_shr:8 row_mask:0xf bank_mask:0xf bound_ctrl:0
    s_nop 1
    v_add_u32_dpp v6, v6, v6 row_bcast:15 row_mask:0xa bank_mask:0xf
    s_nop 1
    v_add_u32_dpp v6, v6, v6 row_bcast:31 row_mask:0xc bank_mask:0xf
    v_sub_u32 v5, v6, v10
    v_readlane_b32 s16, v6, 63
    v_add3_u32 v4, v5, v6, v9
    v_cvt_f32_u32 v4, v4
    s_branch K3_CLAMPED
K3_LIMIT:
    s_cmp_lg_u32 s19, 0
    s_cbranch_scc1 K3_PLACED
    v_add_lshl_u32 v3, v8, v10, 2
    s_flbit_i32_b64 s62, s[86:87]
    s_xor_b32 s62, s62, 63
    v_readlane_b32 s18, v3, s62
    s_mov_b64 s[88:89], 0
    s_waitcnt lgkmcnt(0)
    s_mov_b64 exec, s[72:73]
    v_add_lshl_u32 v56, v56, v67, 2
    v_cmp_gt_u32 vcc, s18, v56
    v_lshlrev_b32 v48, 2, v56
    s_andn2_b64 s[16:17], exec, vcc
    s_or_b64 s[88:89], s[88:89], s[16:17]
    s_mov_b64 exec, vcc
    ds_write_b32 v56, v66 offset:1024
    ds_write_b64 v48, v[64:65] offset:38176
    v_or_b32 v7, 1, v7
    s_mov_b64 exec, s[74:75]
    v_add_lshl_u32 v57, v57, v71, 2
    v_cmp_gt_u32 vcc, s18, v57
    v_lshlrev_b32 v49, 2, v57
    s_andn2_b64 s[16:17], exec, vcc
    s_or_b64 s[88:89], s[88:89], s[16:17]
    s_mov_b64 exec, vcc
    ds_write_b32 v57, v70 offset:1024
    ds_write_b64 v49, v[68:69] offset:38176
    v_or_b32 v7, 2, v7
    s_mov_b64 exec, s[76:77]
    v_add_lshl_u32 v58, v58, v75, 2
    v_cmp_gt_u32 vcc, s18, v58
    v_lshlrev_b32 v50, 2, v58
    s_andn2_b64 s[16:17], exec, vcc
    s_or_b64 s[88:89], s[88:89], s[16:17]
    s_mov_b64 exec, vcc
    ds_write_b32 v58, v74 offset:1024
    ds_write_b64 v50, v[72:73] offset:38176
    v_or_b32 v7, 4, v7
    s_mov_b64 exec, s[78:79]
    v_add_lshl_u32 v59, v59, v79, 2
    v_cmp_gt_u32 vcc, s18, v59
    v_lshlrev_b32 v51, 2, v59
    s_andn2_b64 s[16:17], exec, vcc
    s_or_b64 s[88:89], s[88:89], s[16:17]
    s_mov_b64 exec, vcc
    ds_write_b32 v59, v78 offset:1024
    ds_write_b64 v51, v[76:77] offset:38176
    v_or_b32 v7, 8, v7
    s_mov_b64 exec, s[80:81]
    v_add_lshl_u32 v60, v60, v83, 2
    v_cmp_gt_u32 vcc, s18, v60
    v_lshlrev_b32 v52, 2, v60
    s_andn2_b64 s[16:17], exec, vcc
    s_or_b64 s[88:89], s[88:89], s[16:17]
    s_mov_b64 exec, vcc
    ds_write_b32 v60, v82 offset:1024
    ds_write_b64 v52, v[80:81] offset:38176
    v_or_b32 v7, 16, v7
    s_mov_b64 exec, s[82:83]
    v_add_lshl_u32 v61, v61, v87, 2
    v_cmp_gt_u32 vcc, s18, v61
    v_lshlrev_b32 v53, 2, v61
    s_andn2_b64 s[16:17], exec, vcc
    s_or_b64 s[88:89], s[88:89], s[16:17]
    s_mov_b64 exec, vcc
    ds_write_b32 v61, v86 offset:1024
    ds_write_b64 v53, v[84:85] offset:38176
    v_or_b32 v7, 32, v7
    s_mov_b64 exec, -1
    v_lshlrev_b32 v6, 2, v125
    v_add_u32 v6, 122128, v6
    ds_write_b32 v6, v7
    s_cmp_eq_u64 s[88:89], 0
    s_cbranch_scc1 L_flag_2
    v_mov_b32 v6, 0
    v_mov_b32 v7, 1
    ds_write_b32 v6, v7 offset:256
L_flag_2:
    s_branch K3_LIMITED
K3_QWAVE:
    s_lshl_b32 s14, s3, 13
    s_add_u32 s14, s14, 11268608
    v_lshl_add_u32 v2, v0, 2, s14
    v_add_u32 v3, 0x1000, v2
    buffer_load_dwordx4 v[64:67], v2, s[20:23], 0 offen offset:0
    buffer_load_dwordx4 v[68:71], v2, s[20:23], 0 offen offset:1024
    buffer_load_dwordx4 v[72:75], v2, s[20:23], 0 offen offset:2048
    buffer_load_dwordx4 v[76:79], v2, s[20:23], 0 offen offset:3072
    buffer_load_dwordx4 v[80:83], v3, s[20:23], 0 offen offset:0
    buffer_load_dwordx4 v[84:87], v3, s[20:23], 0 offen offset:1024
    buffer_load_dwordx4 v[88:91], v3, s[20:23], 0 offen offset:2048
    buffer_load_dwordx4 v[92:95], v3, s[20:23], 0 offen offset:3072
    s_lshl_b32 s14, s3, 7
    s_add_u32 s15, s14, 11498496
    v_and_b32 v2, 124, v0
    v_add_u32 v3, s15, v2
    buffer_load_dword v1, v3, s[20:23], 0 offen
    s_and_b32 s14, s3, 1
    s_lshl_b32 s14, s14, 10
    v_lshl_add_u32 v43, v0, 2, s14
    v_add_u32 v2, 11497984, v43
    buffer_load_dwordx4 v[44:47], v2, s[20:23], 0 offen
    s_waitcnt vmcnt(10)
    ds_write_b128 v12, v[8:11]
    s_waitcnt lgkmcnt(0)
    s_barrier
    s_and_b32 s14, s2, 31
    s_lshl_b32 s14, s14, 2
    s_add_u32 s14, s14, s3
    s_sub_u32 s14, s14, 12
    s_mul_i32 s14, s14, 25152
    v_lshl_add_u32 v2, v0, 5, s14
    buffer_load_dword v96, v2, s[20:23], 0 offen
    v_bfe_u32 v2, v0, 3, 1
    v_bfe_u32 v3, v0, 5, 2
    v_lshl_add_u32 v2, v3, 1, v2
    s_mov_b32 s72, 0x05050505
    s_mov_b32 s73, 0x50505050
    s_mov_b32 s74, 0x0a0a0a0a
    s_mov_b32 s75, 0xa0a0a0a0
    s_or_b64 s[76:77], s[72:73], s[74:75]
    v_lshlrev_b32 v4, 4, v2
    v_and_b32 v5, 4, v0
    v_lshlrev_b32 v5, 1, v5
    v_sub_u32 v4, v4, v5
    v_add_u32 v4, 38176, v4
    v_mov_b32 v5, 576
    v_mov_b32 v6, 0x80
    v_cndmask_b32 v14, 0, v6, s[76:77]
    v_cndmask_b32 v13, v5, v4, s[76:77]
    v_mov_b32 v3, 0x3f80
    s_mov_b32 s76, 0x0000000f
    s_mov_b32 s77, 0x000f0000
    v_cndmask_b32 v108, 0, v3, s[76:77]
    s_mov_b32 s78, 0x00000f00
    s_mov_b32 s79, 0x0f000000
    v_cndmask_b32 v109, 0, v3, s[78:79]
    s_mov_b32 s76, 0x000000f0
    s_mov_b32 s77, 0x00f00000
    v_cndmask_b32 v110, 0, v3, s[76:77]
    s_mov_b32 s78, 0x0000f000
    s_mov_b32 s79, 0xf0000000
    v_cndmask_b32 v111, 0, v3, s[78:79]
    v_bfe_u32 v3, v0, 2, 2
    v_mul_u32_u24 v112, 0x1111, v3
    v_pk_mov_b32 v[120:121], 0, 0
    v_and_b32 v2, 124, v0
    v_lshrrev_b32 v3, 7, v0
    v_mul_u32_u24 v122, 68, v2
    v_lshl_add_u32 v122, v3, 4, v122
    v_add_u32 v122, 126224, v122
    s_lshl_b32 s14, s3, 7
    s_add_u32 s14, s14, 70416
    v_mul_u32_u24 v123, 4096, v3
    v_add3_u32 v123, v123, v2, s14
    s_setprio 3
    s_barrier
    s_waitcnt vmcnt(1)
    ds_write_b128 v43, v[44:47] offset:36112
    s_call_b64 s[66:67], K3_QSUB
    s_waitcnt lgkmcnt(0)
    s_barrier
    s_mov_b32 s19, 1
    v_add_u32 v123, 512, v123
    s_waitcnt vmcnt(0)
    s_call_b64 s[66:67], K3_QSUB
    v_mov_b32 v2, 0
    v_mov_b32 v3, 1
    s_mov_b64 exec, 1
    ds_add_u32 v2, v3 offset:292
    s_mov_b64 exec, -1
    v_mov_b32 v7, 0
    s_mov_b64 s[80:81], 0
    s_mov_b64 s[82:83], 0
    s_mov_b64 s[84:85], 0
    s_branch K3_SCAN
K3_LOOPEND:
    s_setprio 0
    v_cmp_u_f32 s[82:83], v120, v121
    s_and_b32 s17, s3, 3
    s_lshl_b32 s16, s17, 2
    v_mov_b32 v2, s16
    v_mov_b32 v3, 1
    s_mov_b64 exec, 1
    s_waitcnt lgkmcnt(0)
    ds_add_rtn_u32 v4, v2, v3 offset:296
    s_mov_b64 exec, -1
    s_cmp_eq_u64 s[82:83], 0
    s_cbranch_scc1 L_flag_3
    v_mov_b32 v2, 0
    v_mov_b32 v3, 1
    ds_write_b32 v2, v3 offset:264
L_flag_3:
    v_lshlrev_b32 v5, 2, v0
    s_waitcnt lgkmcnt(0)
    v_readfirstlane_b32 s16, v4
    s_cmp_ge_u32 s16, 2
    s_cbranch_scc1 K3_NOROLE
    s_lshl_b32 s56, s16, 2
    s_or_b32 s56, s56, s17
    s_lshl_b32 s18, s17, 14
    s_add_u32 s18, s18, 11432448
    v_add_u32 v5, s18, v5
    buffer_load_dwordx4 v[16:19], v5, s[20:23], 0 offen offset:0
    buffer_load_dwordx4 v[20:23], v5, s[20:23], 0 offen offset:1024
    buffer_load_dwordx4 v[24:27], v5, s[20:23], 0 offen offset:2048
    buffer_load_dwordx4 v[28:31], v5, s[20:23], 0 offen offset:3072
    v_add_u32 v5, 0x1000, v5
    buffer_load_dwordx4 v[32:35], v5, s[20:23], 0 offen offset:0
    buffer_load_dwordx4 v[36:39], v5, s[20:23], 0 offen offset:1024
    buffer_load_dwordx4 v[40:43], v5, s[20:23], 0 offen offset:2048
    buffer_load_dwordx4 v[44:47], v5, s[20:23], 0 offen offset:3072
    v_add_u32 v5, 0x1000, v5
    buffer_load_dwordx4 v[48:51], v5, s[20:23], 0 offen offset:0
    buffer_load_dwordx4 v[52:55], v5, s[20:23], 0 offen offset:1024
    buffer_load_dwordx4 v[56:59], v5, s[20:23], 0 offen offset:2048
    buffer_load_dwordx4 v[60:63], v5, s[20:23], 0 offen offset:3072
    v_add_u32 v5, 0x1000, v5
    buffer_load_dwordx4 v[64:67], v5, s[20:23], 0 offen offset:0
    buffer_load_dwordx4 v[68:71], v5, s[20:23], 0 offen offset:1024
    buffer_load_dwordx4 v[72:75], v5, s[20:23], 0 offen offset:2048
    buffer_load_dwordx4 v[76:79], v5, s[20:23], 0 offen offset:3072
    v_and_b32 v2, 60, v0
    v_lshrrev_b32 v3, 6, v0
    s_lshl_b32 s19, s17, 6
    v_add_u32 v124, s19, v2
    global_load_dword v11, v124, s[8:9]
    s_lshl_b32 s19, s16, 7
    v_add_u32 v4, s19, v2
    v_mul_u32_u24 v1, 132, v4
    v_lshl_add_u32 v1, v3, 4, v1
    v_lshl_add_u32 v4, v3, 4, s19
    v_lshl_add_u32 v124, v4, 6, v124
    ds_read_b128 v[12:15], v4 offset:320
    ds_read_b128 v[120:123], v4 offset:384
    v_mov_b32 v6, 0
    s_mov_b32 s14, 0xbf317218
    s_lshl_b32 s15, s39, 6
    v_add_u32 v124, s15, v124
    s_waitcnt lgkmcnt(0)
    v_cvt_f32_u32 v12, v12
    v_cvt_f32_u32 v13, v13
    v_cvt_f32_u32 v14, v14
    v_cvt_f32_u32 v15, v15
    v_cvt_f32_u32 v120, v120
    v_cvt_f32_u32 v121, v121
    v_cvt_f32_u32 v122, v122
    v_cvt_f32_u32 v123, v123
    s_waitcnt vmcnt(0)
    v_lshlrev_b32 v10, 16, v11
    v_and_b32 v11, 0xffff0000, v11
    v_mul_f32 v10, 0xbfb8aa3b, v10
    v_mul_f32 v11, 0xbfb8aa3b, v11
    v_mul_f32 v2, v12, v10
    v_mul_f32 v6, v12, v11
    v_mul_f32 v3, v13, v10
    v_mul_f32 v7, v13, v11
    v_mul_f32 v4, v14, v10
    v_mul_f32 v8, v14, v11
    v_mul_f32 v5, v15, v10
    v_mul_f32 v9, v15, v11
    v_mul_f32 v112, v120, v10
    v_mul_f32 v116, v120, v11
    v_mul_f32 v113, v121, v10
    v_mul_f32 v117, v121, v11
    v_mul_f32 v114, v122, v10
    v_mul_f32 v118, v122, v11
    v_mul_f32 v115, v123, v10
    v_mul_f32 v119, v123, v11
    v_mov_b32 v10, 0
    v_add_u32 v11, 0x1000, v124
    s_or_b32 s13, s13, s38
    s_barrier
    ds_read_b96 v[108:110], v10 offset:256
    ds_read_b128 v[80:83], v1 offset:10240
    ds_read_b128 v[84:87], v1 offset:10304
    ds_read_b128 v[88:91], v1 offset:10368
    ds_read_b128 v[92:95], v1 offset:10432
    ds_read_b128 v[96:99], v1 offset:10496
    ds_read_b128 v[100:103], v1 offset:10560
    ds_read_b128 v[104:107], v1 offset:10624
    s_waitcnt lgkmcnt(7)
    v_or_b32 v10, v108, v109
    v_readfirstlane_b32 s17, v108
    v_readfirstlane_b32 s19, v110
    v_readfirstlane_b32 s18, v10
    ds_read_b128 v[108:111], v1 offset:10688
    s_cmp_lg_u32 s19, 0
    s_cbranch_scc1 K3_GOSAFE
    s_waitcnt lgkmcnt(7)
    v_mfma_f32_16x16x32_bf16 v[2:5], v[80:83], v[16:19], v[2:5]
    v_mfma_f32_16x16x32_bf16 v[6:9], v[80:83], v[48:51], v[6:9]
    ds_read_b128 v[80:83], v1 offset:18688
    s_waitcnt lgkmcnt(7)
    v_mfma_f32_16x16x32_bf16 v[2:5], v[84:87], v[20:23], v[2:5]
    v_mfma_f32_16x16x32_bf16 v[6:9], v[84:87], v[52:55], v[6:9]
    ds_read_b128 v[84:87], v1 offset:18752
    s_waitcnt lgkmcnt(7)
    v_mfma_f32_16x16x32_bf16 v[2:5], v[88:91], v[24:27], v[2:5]
    v_mfma_f32_16x16x32_bf16 v[6:9], v[88:91], v[56:59], v[6:9]
    ds_read_b128 v[88:91], v1 offset:18816
    s_waitcnt lgkmcnt(7)
    v_mfma_f32_16x16x32_bf16 v[2:5], v[92:95], v[28:31], v[2:5]
    v_mfma_f32_16x16x32_bf16 v[6:9], v[92:95], v[60:63], v[6:9]
    ds_read_b128 v[92:95], v1 offset:18880
    s_waitcnt lgkmcnt(7)
    v_mfma_f32_16x16x32_bf16 v[2:5], v[96:99], v[32:35], v[2:5]
    v_mfma_f32_16x16x32_bf16 v[6:9], v[96:99], v[64:67], v[6:9]
    ds_read_b128 v[96:99], v1 offset:18944
    s_waitcnt lgkmcnt(7)
    v_mfma_f32_16x16x32_bf16 v[2:5], v[100:103], v[36:39], v[2:5]
    v_mfma_f32_16x16x32_bf16 v[6:9], v[100:103], v[68:71], v[6:9]
    ds_read_b128 v[100:103], v1 offset:19008
    s_waitcnt lgkmcnt(7)
    v_mfma_f32_16x16x32_bf16 v[2:5], v[104:107], v[40:43], v[2:5]
    v_mfma_f32_16x16x32_bf16 v[6:9], v[104:107], v[72:75], v[6:9]
    ds_read_b128 v[104:107], v1 offset:19072
    s_waitcnt lgkmcnt(7)
    v_mfma_f32_16x16x32_bf16 v[2:5], v[108:111], v[44:47], v[2:5]
    v_mfma_f32_16x16x32_bf16 v[6:9], v[108:111], v[76:79], v[6:9]
    ds_read_b128 v[108:111], v1 offset:19136
    s_or_b32 s16, s13, s18
    s_cbranch_scc1 K3_SLOWEP
    s_waitcnt lgkmcnt(7)
    v_mfma_f32_16x16x32_bf16 v[112:115], v[80:83], v[16:19], v[112:115]
    v_mfma_f32_16x16x32_bf16 v[116:119], v[80:83], v[48:51], v[116:119]
    s_waitcnt lgkmcnt(6)
    v_mfma_f32_16x16x32_bf16 v[112:115], v[84:87], v[20:23], v[112:115]
    v_mfma_f32_16x16x32_bf16 v[116:119], v[84:87], v[52:55], v[116:119]
    s_waitcnt lgkmcnt(5)
    v_mfma_f32_16x16x32_bf16 v[112:115], v[88:91], v[24:27], v[112:115]
    v_mfma_f32_16x16x32_bf16 v[116:119], v[88:91], v[56:59], v[116:119]
    s_waitcnt lgkmcnt(4)
    v_mfma_f32_16x16x32_bf16 v[112:115], v[92:95], v[28:31], v[112:115]
    v_mfma_f32_16x16x32_bf16 v[116:119], v[92:95], v[60:63], v[116:119]
    v_mul_f32 v2, s14, v2
    v_mul_f32 v6, s14, v6
    v_cvt_pk_bf16_f32 v2, v2, v6
    buffer_store_dword v2, v124, s[32:35], 0 offen offset:0 sc1
    s_waitcnt lgkmcnt(3)
    v_mfma_f32_16x16x32_bf16 v[112:115], v[96:99], v[32:35], v[112:115]
    v_mfma_f32_16x16x32_bf16 v[116:119], v[96:99], v[64:67], v[116:119]
    v_mul_f32 v3, s14, v3
    v_mul_f32 v7, s14, v7
    v_cvt_pk_bf16_f32 v3, v3, v7
    buffer_store_dword v3, v124, s[32:35], 0 offen offset:256 sc1
    s_waitcnt lgkmcnt(2)
    v_mfma_f32_16x16x32_bf16 v[112:115], v[100:103], v[36:39], v[112:115]
    v_mfma_f32_16x16x32_bf16 v[116:119], v[100:103], v[68:71], v[116:119]
    v_mul_f32 v4, s14, v4
    v_mul_f32 v8, s14, v8
    v_cvt_pk_bf16_f32 v4, v4, v8
    buffer_store_dword v4, v124, s[32:35], 0 offen offset:512 sc1
    s_waitcnt lgkmcnt(1)
    v_mfma_f32_16x16x32_bf16 v[112:115], v[104:107], v[40:43], v[112:115]
    v_mfma_f32_16x16x32_bf16 v[116:119], v[104:107], v[72:75], v[116:119]
    v_mul_f32 v5, s14, v5
    v_mul_f32 v9, s14, v9
    v_cvt_pk_bf16_f32 v5, v5, v9
    buffer_store_dword v5, v124, s[32:35], 0 offen offset:768 sc1
    s_waitcnt lgkmcnt(0)
    v_mfma_f32_16x16x32_bf16 v[112:115], v[108:111], v[44:47], v[112:115]
    v_mfma_f32_16x16x32_bf16 v[116:119], v[108:111], v[76:79], v[116:119]
    s_nop 6
    v_mul_f32 v112, s14, v112
    v_mul_f32 v116, s14, v116
    v_cvt_pk_bf16_f32 v112, v112, v116
    buffer_store_dword v112, v11, s[32:35], 0 offen offset:0 sc1
    v_mul_f32 v113, s14, v113
    v_mul_f32 v117, s14, v117
    v_cvt_pk_bf16_f32 v113, v113, v117
    buffer_store_dword v113, v11, s[32:35], 0 offen offset:256 sc1
    v_mul_f32 v114, s14, v114
    v_mul_f32 v118, s14, v118
    v_cvt_pk_bf16_f32 v114, v114, v118
    buffer_store_dword v114, v11, s[32:35], 0 offen offset:512 sc1
    v_mul_f32 v115, s14, v115
    v_mul_f32 v119, s14, v119
    v_cvt_pk_bf16_f32 v115, v115, v119
    buffer_store_dword v115, v11, s[32:35], 0 offen offset:768 sc1
    s_endpgm
K3_SLOWEP:
    s_waitcnt lgkmcnt(7)
    v_mfma_f32_16x16x32_bf16 v[112:115], v[80:83], v[16:19], v[112:115]
    v_mfma_f32_16x16x32_bf16 v[116:119], v[80:83], v[48:51], v[116:119]
    s_waitcnt lgkmcnt(6)
    v_mfma_f32_16x16x32_bf16 v[112:115], v[84:87], v[20:23], v[112:115]
    v_mfma_f32_16x16x32_bf16 v[116:119], v[84:87], v[52:55], v[116:119]
    s_waitcnt lgkmcnt(5)
    v_mfma_f32_16x16x32_bf16 v[112:115], v[88:91], v[24:27], v[112:115]
    v_mfma_f32_16x16x32_bf16 v[116:119], v[88:91], v[56:59], v[116:119]
    s_waitcnt lgkmcnt(4)
    v_mfma_f32_16x16x32_bf16 v[112:115], v[92:95], v[28:31], v[112:115]
    v_mfma_f32_16x16x32_bf16 v[116:119], v[92:95], v[60:63], v[116:119]
    s_waitcnt lgkmcnt(3)
    v_mfma_f32_16x16x32_bf16 v[112:115], v[96:99], v[32:35], v[112:115]
    v_mfma_f32_16x16x32_bf16 v[116:119], v[96:99], v[64:67], v[116:119]
    s_waitcnt lgkmcnt(2)
    v_mfma_f32_16x16x32_bf16 v[112:115], v[100:103], v[36:39], v[112:115]
    v_mfma_f32_16x16x32_bf16 v[116:119], v[100:103], v[68:71], v[116:119]
    s_waitcnt lgkmcnt(1)
    v_mfma_f32_16x16x32_bf16 v[112:115], v[104:107], v[40:43], v[112:115]
    v_mfma_f32_16x16x32_bf16 v[116:119], v[104:107], v[72:75], v[116:119]
    s_waitcnt lgkmcnt(0)
    v_mfma_f32_16x16x32_bf16 v[112:115], v[108:111], v[44:47], v[112:115]
    v_mfma_f32_16x16x32_bf16 v[116:119], v[108:111], v[76:79], v[116:119]
    v_cmp_lt_f32 s[72:73], 0, v12
    v_cmp_lt_f32 s[74:75], 0, v13
    v_cmp_lt_f32 s[76:77], 0, v14
    v_cmp_lt_f32 s[78:79], 0, v15
    v_cmp_lt_f32 s[80:81], 0, v120
    v_cmp_lt_f32 s[82:83], 0, v121
    v_cmp_lt_f32 s[84:85], 0, v122
    v_cmp_lt_f32 s[86:87], 0, v123
    s_or_b32 s16, s18, s38
    v_mul_f32 v80, s14, v2
    v_cndmask_b32 v80, 0, v80, s[72:73]
    v_mul_f32 v84, s14, v6
    v_cndmask_b32 v84, 0, v84, s[72:73]
    v_mul_f32 v81, s14, v3
    v_cndmask_b32 v81, 0, v81, s[74:75]
    v_mul_f32 v85, s14, v7
    v_cndmask_b32 v85, 0, v85, s[74:75]
    v_mul_f32 v82, s14, v4
    v_cndmask_b32 v82, 0, v82, s[76:77]
    v_mul_f32 v86, s14, v8
    v_cndmask_b32 v86, 0, v86, s[76:77]
    v_mul_f32 v83, s14, v5
    v_cndmask_b32 v83, 0, v83, s[78:79]
    v_mul_f32 v87, s14, v9
    v_cndmask_b32 v87, 0, v87, s[78:79]
    v_mul_f32 v88, s14, v112
    v_cndmask_b32 v88, 0, v88, s[80:81]
    v_mul_f32 v92, s14, v116
    v_cndmask_b32 v92, 0, v92, s[80:81]
    v_mul_f32 v89, s14, v113
    v_cndmask_b32 v89, 0, v89, s[82:83]
    v_mul_f32 v93, s14, v117
    v_cndmask_b32 v93, 0, v93, s[82:83]
    v_mul_f32 v90, s14, v114
    v_cndmask_b32 v90, 0, v90, s[84:85]
    v_mul_f32 v94, s14, v118
    v_cndmask_b32 v94, 0, v94, s[84:85]
    v_mul_f32 v91, s14, v115
    v_cndmask_b32 v91, 0, v91, s[86:87]
    v_mul_f32 v95, s14, v119
    v_cndmask_b32 v95, 0, v95, s[86:87]
    s_cbranch_scc1 K3_RARE
K3_STORE:
    v_add_u32 v1, 0x1000, v124
    v_cvt_pk_bf16_f32 v24, v80, v84
    buffer_store_dword v24, v124, s[32:35], 0 offen offset:0
    v_cvt_pk_bf16_f32 v25, v81, v85
    buffer_store_dword v25, v124, s[32:35], 0 offen offset:256
    v_cvt_pk_bf16_f32 v26, v82, v86
    buffer_store_dword v26, v124, s[32:35], 0 offen offset:512
    v_cvt_pk_bf16_f32 v27, v83, v87
    buffer_store_dword v27, v124, s[32:35], 0 offen offset:768
    v_cvt_pk_bf16_f32 v28, v88, v92
    buffer_store_dword v28, v1, s[32:35], 0 offen offset:0
    v_cvt_pk_bf16_f32 v29, v89, v93
    buffer_store_dword v29, v1, s[32:35], 0 offen offset:256
    v_cvt_pk_bf16_f32 v30, v90, v94
    buffer_store_dword v30, v1, s[32:35], 0 offen offset:512
    v_cvt_pk_bf16_f32 v31, v91, v95
    buffer_store_dword v31, v1, s[32:35], 0 offen offset:768
    s_endpgm
K3_NOROLE:
    v_mov_b32 v6, 0
    s_barrier
    ds_read_b128 v[112:115], v6 offset:256
    s_waitcnt lgkmcnt(0)
    v_or_b32 v6, v112, v113
    v_readfirstlane_b32 s17, v112
    v_readfirstlane_b32 s19, v114
    v_readfirstlane_b32 s18, v6
    s_cmp_lg_u32 s19, 0
    s_cbranch_scc1 K3_GOSAFE
    s_mov_b32 s38, 1
    s_cmp_lg_u32 s18, 0
    s_cbranch_scc1 K3_NEXT
    s_endpgm
K3_RARE:
    s_lshl_b32 s16, s2, 15
    s_lshl_b32 s15, s56, 12
    s_add_u32 s16, s16, s15
    s_add_u32 s16, s16, 14720512
    v_lshl_add_u32 v1, v0, 4, s16
    s_cmp_eq_u32 s38, 0
    s_cbranch_scc1 K3_NOPREV
    buffer_load_dwordx4 v[16:19], v1, s[20:23], 0 offen offset:0 sc0 sc1
    buffer_load_dwordx4 v[20:23], v1, s[20:23], 0 offen offset:16 sc0 sc1
    buffer_load_dwordx4 v[24:27], v1, s[20:23], 0 offen offset:32 sc0 sc1
    buffer_load_dwordx4 v[28:31], v1, s[20:23], 0 offen offset:48 sc0 sc1
    s_waitcnt vmcnt(0)
    v_add_f32 v80, v80, v16
    v_add_f32 v81, v81, v17
    v_add_f32 v82, v82, v18
    v_add_f32 v83, v83, v19
    v_add_f32 v84, v84, v20
    v_add_f32 v85, v85, v21
    v_add_f32 v86, v86, v22
    v_add_f32 v87, v87, v23
    v_add_f32 v88, v88, v24
    v_add_f32 v89, v89, v25
    v_add_f32 v90, v90, v26
    v_add_f32 v91, v91, v27
    v_add_f32 v92, v92, v28
    v_add_f32 v93, v93, v29
    v_add_f32 v94, v94, v30
    v_add_f32 v95, v95, v31
    s_cmp_eq_u32 s18, 0
    s_cbranch_scc1 K3_STORE
K3_NOPREV:
    buffer_store_dwordx4 v[80:83], v1, s[20:23], 0 offen offset:0 sc0 sc1
    buffer_store_dwordx4 v[84:87], v1, s[20:23], 0 offen offset:16 sc0 sc1
    buffer_store_dwordx4 v[88:91], v1, s[20:23], 0 offen offset:32 sc0 sc1
    buffer_store_dwordx4 v[92:95], v1, s[20:23], 0 offen offset:48 sc0 sc1
    s_mov_b32 s38, 1
    s_branch K3_NEXT
K3_GOSAFE:
    s_mov_b32 s37, 1
    s_mov_b32 s38, 0
    s_mov_b32 s36, -1
    s_mov_b32 s17, 0
K3_NEXT:
    s_mov_b32 s55, 1
    v_lshlrev_b32 v1, 2, v125
    v_add_u32 v1, 122128, v1
    ds_read_b32 v1, v1
    s_waitcnt vmcnt(0) lgkmcnt(0)
    s_cmp_lg_u32 s17, 0
    s_cbranch_scc1 K3_SAMEWIN
    s_add_u32 s36, s36, 1
    v_mov_b32 v1, 0
K3_SAMEWIN:
    s_barrier
    s_lshl_b32 s14, s3, 10
    v_lshl_add_u32 v3, v0, 2, s14
    s_add_u32 s14, s14, 1024
    s_cmp_lt_u32 s3, 9
    s_cselect_b32 s15, 3200000, 0
    s_cselect_b32 s14, s14, 0
    v_lshl_add_u32 v2, v0, 2, s14
    v_pk_mov_b32 v[4:5], 0, 0
    v_pk_mov_b32 v[6:7], 0, 0
    ds_write_b128 v3, v[4:7] offset:38160
    ds_write_b128 v3, v[4:7] offset:54544
    v_mov_b32 v4, s15
    v_mov_b32 v5, s15
    v_mov_b32 v6, s15
    v_mov_b32 v7, s15
    ds_write_b128 v2, v[4:7]
    v_bfe_u32 v2, v0, 3, 1
    v_bfe_u32 v3, v0, 5, 2
    v_lshl_add_u32 v2, v3, 1, v2
    s_mov_b32 s72, 0x05050505
    s_mov_b32 s73, 0x50505050
    s_mov_b32 s74, 0x0a0a0a0a
    s_mov_b32 s75, 0xa0a0a0a0
    s_or_b64 s[76:77], s[72:73], s[74:75]
    v_lshlrev_b32 v4, 4, v2
    v_and_b32 v5, 4, v0
    v_lshlrev_b32 v5, 1, v5
    v_sub_u32 v4, v4, v5
    v_add_u32 v4, 38176, v4
    v_mov_b32 v5, 576
    v_mov_b32 v6, 0x80
    v_cndmask_b32 v14, 0, v6, s[76:77]
    v_cndmask_b32 v13, v5, v4, s[76:77]
    v_mov_b32 v3, 0x3f80
    s_mov_b32 s76, 0x0000000f
    s_mov_b32 s77, 0x000f0000
    v_cndmask_b32 v108, 0, v3, s[76:77]
    s_mov_b32 s78, 0x00000f00
    s_mov_b32 s79, 0x0f000000
    v_cndmask_b32 v109, 0, v3, s[78:79]
    s_mov_b32 s76, 0x000000f0
    s_mov_b32 s77, 0x00f00000
    v_cndmask_b32 v110, 0, v3, s[76:77]
    s_mov_b32 s78, 0x0000f000
    s_mov_b32 s79, 0xf0000000
    v_cndmask_b32 v111, 0, v3, s[78:79]
    v_bfe_u32 v3, v0, 2, 2
    v_mul_u32_u24 v112, 0x1111, v3
    v_pk_mov_b32 v[120:121], 0, 0
    v_mov_b32 v7, v1
    v_and_b32 v2, 0xffff, v126
    v_lshrrev_b32 v3, 16, v126
    v_mul_u32_u24 v6, 10923, v125
    v_lshrrev_b32 v6, 16, v6
    v_mul_u32_u24 v15, 6, v6
    v_sub_u32 v15, v125, v15
    v_mul_u32_u24 v124, 3200, v6
    v_add_u32 v124, v124, v15
    s_mul_i32 s14, s36, 36
    v_add_u32 v15, s14, v15
    v_add_u32 v124, s14, v124
    v_add_u32 v2, v2, v124
    v_sub_u32 v3, v3, v15
    v_mul_u32_u24 v2, 12, v2
    v_add_u32 v2, 6438912, v2
    v_cmp_lt_i32 s[72:73], 0, v3
    v_cmp_lt_i32 s[74:75], 6, v3
    v_cmp_lt_i32 s[76:77], 12, v3
    v_cmp_lt_i32 s[78:79], 18, v3
    v_cmp_lt_i32 s[80:81], 24, v3
    v_cmp_lt_i32 s[82:83], 30, v3
    v_cmp_lt_i32 s[84:85], 36, v3
    s_mov_b64 exec, -1
    v_and_b32 v5, 1, v7
    v_cmp_eq_u32 vcc, 0, v5
    s_and_b64 s[72:73], s[72:73], vcc
    s_mov_b64 exec, s[72:73]
    s_cbranch_execz K3_RLb0
    buffer_load_dwordx3 v[64:66], v2, s[20:23], 0 offen offset:0
K3_RLb0:
    s_mov_b64 exec, -1
    v_and_b32 v5, 2, v7
    v_cmp_eq_u32 vcc, 0, v5
    s_and_b64 s[74:75], s[74:75], vcc
    s_mov_b64 exec, s[74:75]
    s_cbranch_execz K3_RLb1
    buffer_load_dwordx3 v[68:70], v2, s[20:23], 0 offen offset:72
K3_RLb1:
    s_mov_b64 exec, -1
    v_and_b32 v5, 4, v7
    v_cmp_eq_u32 vcc, 0, v5
    s_and_b64 s[76:77], s[76:77], vcc
    s_mov_b64 exec, s[76:77]
    s_cbranch_execz K3_RLb2
    buffer_load_dwordx3 v[72:74], v2, s[20:23], 0 offen offset:144
K3_RLb2:
    s_mov_b64 exec, -1
    v_and_b32 v5, 8, v7
    v_cmp_eq_u32 vcc, 0, v5
    s_and_b64 s[78:79], s[78:79], vcc
    s_mov_b64 exec, s[78:79]
    s_cbranch_execz K3_RLb3
    buffer_load_dwordx3 v[76:78], v2, s[20:23], 0 offen offset:216
K3_RLb3:
    s_mov_b64 exec, -1
    v_and_b32 v5, 16, v7
    v_cmp_eq_u32 vcc, 0, v5
    s_and_b64 s[80:81], s[80:81], vcc
    s_mov_b64 exec, s[80:81]
    s_cbranch_execz K3_RLb4
    buffer_load_dwordx3 v[80:82], v2, s[20:23], 0 offen offset:288
K3_RLb4:
    s_mov_b64 exec, -1
    v_and_b32 v5, 32, v7
    v_cmp_eq_u32 vcc, 0, v5
    s_and_b64 s[82:83], s[82:83], vcc
    s_mov_b64 exec, s[82:83]
    s_cbranch_execz K3_RLb5
    buffer_load_dwordx3 v[84:86], v2, s[20:23], 0 offen offset:360
K3_RLb5:
    s_mov_b64 exec, -1
    s_mov_b32 s19, 0
    s_waitcnt lgkmcnt(0)
    s_barrier
    s_branch K3_INSERT
K3_END:
    s_endpgm
.section .rodata,"a"
.p2align 6
.amdhsa_kernel prep_kernel
  .amdhsa_next_free_vgpr 96
  .amdhsa_next_free_sgpr 96
  .amdhsa_accum_offset 96
  .amdhsa_group_segment_fixed_size 0
  .amdhsa_kernarg_size 88
  .amdhsa_user_sgpr_count 2
  .amdhsa_user_sgpr_kernarg_segment_ptr 1
  .amdhsa_system_sgpr_workgroup_id_x 1
  .amdhsa_float_denorm_mode_32 3
.end_amdhsa_kernel
.p2align 6
.amdhsa_kernel main_kernel
  .amdhsa_next_free_vgpr 128
  .amdhsa_next_free_sgpr 102
  .amdhsa_accum_offset 128
  .amdhsa_group_segment_fixed_size 0
  .amdhsa_kernarg_size 88
  .amdhsa_user_sgpr_count 2
  .amdhsa_user_sgpr_kernarg_segment_ptr 1
  .amdhsa_system_sgpr_workgroup_id_x 1
  .amdhsa_float_denorm_mode_32 3
.end_amdhsa_kernel
```
